```python
import torch

def _softmax(x, axis=-1):
    return torch.softmax(x, dim=axis)
def _gelu(x):
    return torch.nn.functional.gelu(x, approximate="tanh")
def _silu(x):
    return torch.nn.functional.silu(x)
def _sigmoid(x):
    return torch.sigmoid(x)
def _layernorm(x, axis=-1, eps=1e-5):
    m = x.mean(dim=axis, keepdim=True)
    v = x.var(dim=axis, keepdim=True, unbiased=False)
    return (x - m) / torch.sqrt(v + eps)
def _scatter_add(tgt, idx, src, axis=0):
    return tgt.clone().index_add_(axis, idx, src)
def _segment_sum(src, seg, n):
    out = torch.zeros((n,) + src.shape[1:], dtype=src.dtype)
    return out.index_add_(0, seg, src)
def _pad(x, pw):
    flat = tuple(v for pair in reversed(pw) for v in pair)
    return torch.nn.functional.pad(x, flat)

kernel_name = 'concat_heads__linear_attn_block__spectral_gfnet__prompt'

def setup_inputs():

    _w = (lambda a: (lambda t: t.to(torch.bfloat16) if t.is_floating_point() else t)(torch.as_tensor(a)))
    def _A_setup():
        B, S, D = 1, 2048, 1024
        return {
            "x": _w((lambda *s: torch.randn(*s, dtype=torch.bfloat16) * 0.05)(B, S, D)),
            "wqkv": _w((lambda *s: torch.randn(*s, dtype=torch.bfloat16) * 0.4)(D, 3 * D)),
            "wo": _w((lambda *s: torch.randn(*s, dtype=torch.bfloat16) * 0.05)(D, D)),
        }
    _A_in = _A_setup()

    def _B_setup():
        B, S, D = 1, 2048, 1024
        Df = D // 2 + 1
        return {
            "x": _w((lambda *s: torch.randn(*s, dtype=torch.bfloat16) * 0.05)(B, S, D)),
            "w_r": _w((lambda *s: torch.randn(*s, dtype=torch.bfloat16) * 1.6)(S, Df) * 0.02),
            "w_i": _w((lambda *s: torch.randn(*s, dtype=torch.bfloat16) * 1.6)(S, Df) * 0.02),
        }
    _B_in = _B_setup()

    return {
        "A_x": _A_in["x"],
        "A_wqkv": _A_in["wqkv"],
        "A_wo": _A_in["wo"],
        "B_x": _B_in["x"],
        "B_w_r": _B_in["w_r"],
        "B_w_i": _B_in["w_i"],
    }

def reference(A_x, A_wqkv, A_wo, B_x, B_w_r, B_w_i):
    def _A_ref(x, wqkv, wo):
        B, S, D = x.shape
        H = 32; Dh = D // H
        qkv = (lambda x, *d: x.permute(*d))((x @ wqkv).reshape(B, S, 3, H, Dh), 2, 0, 3, 1, 4)
        q, k, v = qkv[0], qkv[1], qkv[2]
        phi = lambda t: torch.where(t > 0, t + 1, torch.exp(t)) + 1e-6
        pq, pk = phi(q), phi(k)
        kv = torch.einsum("bhsd,bhse->bhde", pk, v)
        z = torch.einsum("bhsd->bhd", pk)
        num = torch.einsum("bhqd,bhde->bhqe", pq, kv)
        den = torch.einsum("bhqd,bhd->bhq", pq, z)[..., None] + 1e-6
        o = num / den
        return (lambda x, *d: x.permute(*d))(o, 0, 2, 1, 3).reshape(B, S, D) @ wo

    def _B_ref(x, w_r, w_i):
        B, S, D = x.shape
        X = (lambda x, axes=(-2,-1): torch.fft.rfft2(x.float(), dim=axes))(x, axes=(-2, -1))
        W = w_r + 1j * w_i
        X = X * W
        y = (lambda x, s, axes=(-2,-1): torch.fft.irfft2(x, s=s, dim=axes).to(torch.bfloat16))(X, (S, D), axes=(-2, -1))
        return y

    a = _A_ref(A_x, A_wqkv, A_wo)
    b = _B_ref(B_x, B_w_r, B_w_i)
    return torch.concatenate([a, b], axis=-1)
```

```asm
; @launch grid=(256,1,1) block=(512,1,1) lds=163840
.amdgcn_target "amdgcn-amd-amdhsa--gfx950"
.text

.globl concat_heads__linear_attn_block__spectral_gfnet__prompt_kernel
.p2align 8
.type concat_heads__linear_attn_block__spectral_gfnet__prompt_kernel,@function
concat_heads__linear_attn_block__spectral_gfnet__prompt_kernel:
L_cb:
    s_cmp_ge_u32 s2, 256
    s_cbranch_scc1 L_exit
    s_load_dwordx16 s[4:19], s[0:1], 0
    s_load_dwordx2 s[20:21], s[0:1], 64
    v_lshrrev_b32 v1, 6, v0
    v_and_b32 v0, 63, v0
    s_nop 0
    v_readfirstlane_b32 s3, v1
    s_cmp_ge_u32 s2, 8
    s_cbranch_scc1 L_cpf_1
    s_getpc_b64 s[36:37]
L_cpc_2:
    s_sub_u32 s36, s36, L_cpc_2-L_cb
    s_subb_u32 s37, s37, 0
    s_lshl_b32 s38, s3, 12
    v_lshlrev_b32 v252, 6, v0
    v_add_u32 v252, s38, v252
    v_min_u32 v252, L_exit-L_cb, v252
    v_mov_b32 v255, s37
    v_add_co_u32 v254, vcc, s36, v252
    s_nop 1
    v_addc_co_u32 v255, vcc, 0, v255, vcc
    global_load_dword v253, v[254:255], off
L_cpf_1:
    s_and_b32 s42, s2, 7
    s_lshr_b32 s43, s2, 3
    s_and_b32 s40, s42, 1
    s_lshl_b32 s40, s40, 3
    s_and_b32 s44, s43, 7
    s_add_u32 s40, s40, s44
    s_lshr_b32 s41, s42, 1
    s_lshl_b32 s41, s41, 2
    s_lshr_b32 s44, s43, 3
    s_add_u32 s41, s41, s44
    s_cmp_ge_u32 s3, 4
    s_cbranch_scc1 L_loader
    s_waitcnt lgkmcnt(0)
    s_mov_b32 s24, s4
    s_mov_b32 s25, s5
    s_mov_b32 s26, 4194304
    s_mov_b32 s27, 0x00020000
    s_mov_b32 s28, s6
    s_mov_b32 s29, s7
    s_mov_b32 s30, 6291456
    s_mov_b32 s31, 0x00020000
    s_mov_b32 s32, s20
    s_mov_b32 s33, s21
    s_mov_b32 s34, 268435456
    s_mov_b32 s35, 0x00020000
    v_mov_b32 v249, 0
    buffer_load_dword v248, v249, s[32:35], 0 offen sc1
    v_mov_b32 v180, v0
    s_and_b32 s42, s3, 1
    s_lshr_b32 s43, s3, 1
    v_and_b32 v100, 15, v180
    v_lshrrev_b32 v101, 4, v180
    v_bfe_u32 v102, v100, 1, 3
    s_lshl_b32 s44, s42, 13
    v_lshlrev_b32 v103, 7, v100
    v_add_u32 v103, s44, v103
    v_xor_b32 v104, v101, v102
    v_lshlrev_b32 v104, 4, v104
    v_add_u32 v176, v103, v104
    v_xor_b32 v177, 64, v176
    v_bfe_u32 v102, v180, 2, 2
    v_and_b32 v103, 3, v180
    v_lshlrev_b32 v104, 3, v101
    v_add_u32 v104, v104, v102
    v_lshlrev_b32 v104, 7, v104
    v_lshrrev_b32 v105, 1, v103
    s_lshl_b32 s44, s43, 2
    v_add_u32 v105, s44, v105
    v_bfe_u32 v106, v180, 3, 2
    v_lshlrev_b32 v106, 1, v106
    v_xor_b32 v105, v105, v106
    v_lshlrev_b32 v105, 4, v105
    v_and_b32 v106, 1, v103
    v_lshlrev_b32 v106, 3, v106
    v_add3_u32 v178, v104, v105, v106
    v_xor_b32 v179, 32, v178
    v_mov_b32 v0, 0
    v_mov_b32 v1, 0
    v_mov_b32 v2, 0
    v_mov_b32 v3, 0
    v_mov_b32 v4, 0
    v_mov_b32 v5, 0
    v_mov_b32 v6, 0
    v_mov_b32 v7, 0
    v_mov_b32 v8, 0
    v_mov_b32 v9, 0
    v_mov_b32 v10, 0
    v_mov_b32 v11, 0
    v_mov_b32 v12, 0
    v_mov_b32 v13, 0
    v_mov_b32 v14, 0
    v_mov_b32 v15, 0
    v_mov_b32 v16, 0
    v_mov_b32 v17, 0
    v_mov_b32 v18, 0
    v_mov_b32 v19, 0
    v_mov_b32 v20, 0
    v_mov_b32 v21, 0
    v_mov_b32 v22, 0
    v_mov_b32 v23, 0
    v_mov_b32 v24, 0
    v_mov_b32 v25, 0
    v_mov_b32 v26, 0
    v_mov_b32 v27, 0
    v_mov_b32 v28, 0
    v_mov_b32 v29, 0
    v_mov_b32 v30, 0
    v_mov_b32 v31, 0
    v_mov_b32 v32, 0
    v_mov_b32 v33, 0
    v_mov_b32 v34, 0
    v_mov_b32 v35, 0
    v_mov_b32 v36, 0
    v_mov_b32 v37, 0
    v_mov_b32 v38, 0
    v_mov_b32 v39, 0
    v_mov_b32 v40, 0
    v_mov_b32 v41, 0
    v_mov_b32 v42, 0
    v_mov_b32 v43, 0
    v_mov_b32 v44, 0
    v_mov_b32 v45, 0
    v_mov_b32 v46, 0
    v_mov_b32 v47, 0
    v_mov_b32 v48, 0
    v_mov_b32 v49, 0
    v_mov_b32 v50, 0
    v_mov_b32 v51, 0
    v_mov_b32 v52, 0
    v_mov_b32 v53, 0
    v_mov_b32 v54, 0
    v_mov_b32 v55, 0
    v_mov_b32 v56, 0
    v_mov_b32 v57, 0
    v_mov_b32 v58, 0
    v_mov_b32 v59, 0
    v_mov_b32 v60, 0
    v_mov_b32 v61, 0
    v_mov_b32 v62, 0
    v_mov_b32 v63, 0
    v_mov_b32 v64, 0
    v_mov_b32 v65, 0
    v_mov_b32 v66, 0
    v_mov_b32 v67, 0
    v_mov_b32 v68, 0
    v_mov_b32 v69, 0
    v_mov_b32 v70, 0
    v_mov_b32 v71, 0
    v_mov_b32 v72, 0
    v_mov_b32 v73, 0
    v_mov_b32 v74, 0
    v_mov_b32 v75, 0
    v_mov_b32 v76, 0
    v_mov_b32 v77, 0
    v_mov_b32 v78, 0
    v_mov_b32 v79, 0
    v_mov_b32 v80, 0
    v_mov_b32 v81, 0
    v_mov_b32 v82, 0
    v_mov_b32 v83, 0
    v_mov_b32 v84, 0
    v_mov_b32 v85, 0
    v_mov_b32 v86, 0
    v_mov_b32 v87, 0
    v_mov_b32 v88, 0
    v_mov_b32 v89, 0
    v_mov_b32 v90, 0
    v_mov_b32 v91, 0
    v_mov_b32 v92, 0
    v_mov_b32 v93, 0
    v_mov_b32 v94, 0
    v_mov_b32 v95, 0
    s_mov_b32 s46, 0
    s_mov_b32 s49, 16
    s_setprio 1
    s_barrier
    ds_read_b128 v[96:99], v176 offset:0
    ds_read_b64_tr_b16 v[112:113], v178 offset:16384
    ds_read_b64_tr_b16 v[114:115], v178 offset:16896
    ds_read_b128 v[100:103], v176 offset:2048
    ds_read_b128 v[104:107], v176 offset:4096
    ds_read_b128 v[108:111], v176 offset:6144
    ds_read_b64_tr_b16 v[116:117], v179 offset:16384
    ds_read_b64_tr_b16 v[118:119], v179 offset:16896
    ds_read_b64_tr_b16 v[120:121], v178 offset:24576
    ds_read_b64_tr_b16 v[122:123], v178 offset:25088
    ds_read_b64_tr_b16 v[124:125], v179 offset:24576
    ds_read_b64_tr_b16 v[126:127], v179 offset:25088
    ds_read_b64_tr_b16 v[128:129], v178 offset:32768
    ds_read_b64_tr_b16 v[130:131], v178 offset:33280
    ds_read_b64_tr_b16 v[132:133], v179 offset:32768
    ds_read_b64_tr_b16 v[134:135], v179 offset:33280
L_cons_3:
    s_waitcnt lgkmcnt(13)
    v_mfma_f32_16x16x32_bf16 v[0:3], v[112:115], v[96:99], v[0:3]
    ds_read_b128 v[136:139], v177 offset:0
    s_waitcnt lgkmcnt(13)
    v_mfma_f32_16x16x32_bf16 v[4:7], v[112:115], v[100:103], v[4:7]
    ds_read_b64_tr_b16 v[152:153], v178 offset:20480
    s_waitcnt lgkmcnt(13)
    v_mfma_f32_16x16x32_bf16 v[8:11], v[112:115], v[104:107], v[8:11]
    ds_read_b64_tr_b16 v[154:155], v178 offset:20992
    s_waitcnt lgkmcnt(13)
    v_mfma_f32_16x16x32_bf16 v[12:15], v[112:115], v[108:111], v[12:15]
    ds_read_b128 v[140:143], v177 offset:2048
    s_waitcnt lgkmcnt(12)
    v_mfma_f32_16x16x32_bf16 v[28:31], v[116:119], v[108:111], v[28:31]
    ds_read_b128 v[144:147], v177 offset:4096
    v_mfma_f32_16x16x32_bf16 v[24:27], v[116:119], v[104:107], v[24:27]
    ds_read_b128 v[148:151], v177 offset:6144
    v_mfma_f32_16x16x32_bf16 v[20:23], v[116:119], v[100:103], v[20:23]
    ds_read_b64_tr_b16 v[156:157], v179 offset:20480
    v_mfma_f32_16x16x32_bf16 v[16:19], v[116:119], v[96:99], v[16:19]
    ds_read_b64_tr_b16 v[158:159], v179 offset:20992
    s_waitcnt lgkmcnt(14)
    v_mfma_f32_16x16x32_bf16 v[32:35], v[96:99], v[120:123], v[32:35]
    ds_read_b64_tr_b16 v[160:161], v178 offset:28672
    v_mfma_f32_16x16x32_bf16 v[36:39], v[100:103], v[120:123], v[36:39]
    ds_read_b64_tr_b16 v[162:163], v178 offset:29184
    v_mfma_f32_16x16x32_bf16 v[40:43], v[104:107], v[120:123], v[40:43]
    ds_read_b64_tr_b16 v[164:165], v179 offset:28672
    v_mfma_f32_16x16x32_bf16 v[44:47], v[108:111], v[120:123], v[44:47]
    ds_read_b64_tr_b16 v[166:167], v179 offset:29184
    s_waitcnt lgkmcnt(15)
    v_mfma_f32_16x16x32_bf16 v[60:63], v[108:111], v[124:127], v[60:63]
    ds_read_b64_tr_b16 v[168:169], v178 offset:36864
    v_mfma_f32_16x16x32_bf16 v[56:59], v[104:107], v[124:127], v[56:59]
    ds_read_b64_tr_b16 v[170:171], v178 offset:37376
    v_mfma_f32_16x16x32_bf16 v[52:55], v[100:103], v[124:127], v[52:55]
    ds_read_b64_tr_b16 v[172:173], v179 offset:36864
    v_mfma_f32_16x16x32_bf16 v[48:51], v[96:99], v[124:127], v[48:51]
    ds_read_b64_tr_b16 v[174:175], v179 offset:37376
    s_waitcnt lgkmcnt(15)
    v_mfma_f32_16x16x32_bf16 v[64:67], v[96:99], v[128:131], v[64:67]
    v_mfma_f32_16x16x32_bf16 v[68:71], v[100:103], v[128:131], v[68:71]
    s_add_u32 s46, s46, 1
    s_cmp_eq_u32 s46, 3
    s_cselect_b32 s46, 0, s46
    s_mov_b32 s52, 40960
    s_cselect_b32 s52, 4294885376, s52
    v_add_u32 v176, s52, v176
    v_add_u32 v177, s52, v177
    v_add_u32 v178, s52, v178
    v_add_u32 v179, s52, v179
    v_mfma_f32_16x16x32_bf16 v[72:75], v[104:107], v[128:131], v[72:75]
    v_mfma_f32_16x16x32_bf16 v[76:79], v[108:111], v[128:131], v[76:79]
    v_mfma_f32_16x16x32_bf16 v[92:95], v[108:111], v[132:135], v[92:95]
    v_mfma_f32_16x16x32_bf16 v[88:91], v[104:107], v[132:135], v[88:91]
    v_mfma_f32_16x16x32_bf16 v[84:87], v[100:103], v[132:135], v[84:87]
    v_mfma_f32_16x16x32_bf16 v[80:83], v[96:99], v[132:135], v[80:83]
    s_waitcnt lgkmcnt(0)
    s_barrier
    v_mfma_f32_16x16x32_bf16 v[0:3], v[152:155], v[136:139], v[0:3]
    ds_read_b128 v[96:99], v176 offset:0
    v_mfma_f32_16x16x32_bf16 v[4:7], v[152:155], v[140:143], v[4:7]
    ds_read_b64_tr_b16 v[112:113], v178 offset:16384
    v_mfma_f32_16x16x32_bf16 v[8:11], v[152:155], v[144:147], v[8:11]
    ds_read_b64_tr_b16 v[114:115], v178 offset:16896
    v_mfma_f32_16x16x32_bf16 v[12:15], v[152:155], v[148:151], v[12:15]
    ds_read_b128 v[100:103], v176 offset:2048
    v_mfma_f32_16x16x32_bf16 v[28:31], v[156:159], v[148:151], v[28:31]
    ds_read_b128 v[104:107], v176 offset:4096
    v_mfma_f32_16x16x32_bf16 v[24:27], v[156:159], v[144:147], v[24:27]
    ds_read_b128 v[108:111], v176 offset:6144
    v_mfma_f32_16x16x32_bf16 v[20:23], v[156:159], v[140:143], v[20:23]
    ds_read_b64_tr_b16 v[116:117], v179 offset:16384
    v_mfma_f32_16x16x32_bf16 v[16:19], v[156:159], v[136:139], v[16:19]
    ds_read_b64_tr_b16 v[118:119], v179 offset:16896
    v_mfma_f32_16x16x32_bf16 v[32:35], v[136:139], v[160:163], v[32:35]
    ds_read_b64_tr_b16 v[120:121], v178 offset:24576
    v_mfma_f32_16x16x32_bf16 v[36:39], v[140:143], v[160:163], v[36:39]
    ds_read_b64_tr_b16 v[122:123], v178 offset:25088
    v_mfma_f32_16x16x32_bf16 v[40:43], v[144:147], v[160:163], v[40:43]
    ds_read_b64_tr_b16 v[124:125], v179 offset:24576
    v_mfma_f32_16x16x32_bf16 v[44:47], v[148:151], v[160:163], v[44:47]
    ds_read_b64_tr_b16 v[126:127], v179 offset:25088
    v_mfma_f32_16x16x32_bf16 v[60:63], v[148:151], v[164:167], v[60:63]
    ds_read_b64_tr_b16 v[128:129], v178 offset:32768
    v_mfma_f32_16x16x32_bf16 v[56:59], v[144:147], v[164:167], v[56:59]
    ds_read_b64_tr_b16 v[130:131], v178 offset:33280
    v_mfma_f32_16x16x32_bf16 v[52:55], v[140:143], v[164:167], v[52:55]
    ds_read_b64_tr_b16 v[132:133], v179 offset:32768
    v_mfma_f32_16x16x32_bf16 v[48:51], v[136:139], v[164:167], v[48:51]
    ds_read_b64_tr_b16 v[134:135], v179 offset:33280
    v_mfma_f32_16x16x32_bf16 v[64:67], v[136:139], v[168:171], v[64:67]
    v_mfma_f32_16x16x32_bf16 v[68:71], v[140:143], v[168:171], v[68:71]
    v_mfma_f32_16x16x32_bf16 v[72:75], v[144:147], v[168:171], v[72:75]
    v_mfma_f32_16x16x32_bf16 v[76:79], v[148:151], v[168:171], v[76:79]
    v_mfma_f32_16x16x32_bf16 v[92:95], v[148:151], v[172:175], v[92:95]
    v_mfma_f32_16x16x32_bf16 v[88:91], v[144:147], v[172:175], v[88:91]
    v_mfma_f32_16x16x32_bf16 v[84:87], v[140:143], v[172:175], v[84:87]
    v_mfma_f32_16x16x32_bf16 v[80:83], v[136:139], v[172:175], v[80:83]
    s_sub_u32 s49, s49, 1
    s_cmp_lg_u32 s49, 0
    s_cbranch_scc1 L_cons_3
    s_waitcnt lgkmcnt(0)
    s_setprio 3
    s_waitcnt vmcnt(0)
    v_readfirstlane_b32 s42, v248
    s_mul_i32 s56, s42, 1664525
    s_add_u32 s56, s56, 1013904223
    s_or_b32 s56, s56, 1
    s_cmp_eq_u32 s56, s42
    s_cselect_b32 s43, 2, 0
    s_add_u32 s56, s56, s43
    s_and_b32 s59, s3, 1
    s_lshr_b32 s58, s3, 1
    s_lshl_b32 s42, s41, 1
    s_add_u32 s58, s58, s42
    s_mov_b32 s68, 0x3fb8aa3b
    s_mov_b32 s69, 0x358637bd
    v_mov_b32 v181, s56
    v_mov_b32 v188, 0
    v_lshrrev_b32 v189, 4, v180
    v_bfe_u32 v190, v180, 2, 2
    v_and_b32 v191, 3, v180
    v_cmp_eq_u32 vcc, v189, v190
    s_nop 1
    v_cndmask_b32 v191, 7, v191, vcc
    v_mov_b32 v189, 0x3f80
    v_mov_b32 v190, 0x3f800000
    v_mov_b32 v184, 0
    v_cmp_eq_u32 vcc, 0, v191
    s_nop 1
    v_cndmask_b32 v184, v184, v189, vcc
    v_cmp_eq_u32 vcc, 1, v191
    s_nop 1
    v_cndmask_b32 v184, v184, v190, vcc
    v_mov_b32 v185, 0
    v_cmp_eq_u32 vcc, 2, v191
    s_nop 1
    v_cndmask_b32 v185, v185, v189, vcc
    v_cmp_eq_u32 vcc, 3, v191
    s_nop 1
    v_cndmask_b32 v185, v185, v190, vcc
    v_mov_b32 v182, 0
    v_mov_b32 v183, 0
    v_mov_b32 v186, 0
    v_mov_b32 v187, 0
    v_mov_b32 v168, 0x3f803f80
    v_mov_b32 v169, 0x3f803f80
    v_mov_b32 v170, 0x3f803f80
    v_mov_b32 v171, 0x3f803f80
    v_cvt_pk_bf16_f32 v128, v64, v65
    v_cvt_pk_bf16_f32 v129, v66, v67
    v_cvt_pk_bf16_f32 v130, v68, v69
    v_cvt_pk_bf16_f32 v131, v70, v71
    v_cvt_pk_bf16_f32 v132, v72, v73
    v_cvt_pk_bf16_f32 v133, v74, v75
    v_cvt_pk_bf16_f32 v134, v76, v77
    v_cvt_pk_bf16_f32 v135, v78, v79
    v_cvt_pk_bf16_f32 v136, v80, v81
    v_cvt_pk_bf16_f32 v137, v82, v83
    v_cvt_pk_bf16_f32 v138, v84, v85
    v_cvt_pk_bf16_f32 v139, v86, v87
    v_cvt_pk_bf16_f32 v140, v88, v89
    v_cvt_pk_bf16_f32 v141, v90, v91
    v_cvt_pk_bf16_f32 v142, v92, v93
    v_cvt_pk_bf16_f32 v143, v94, v95
    s_cmp_eq_u32 s59, 0
    s_cbranch_scc1 L_nosw_4
    v_swap_b32 v128, v136
    v_swap_b32 v129, v137
    v_swap_b32 v130, v138
    v_swap_b32 v131, v139
    v_swap_b32 v132, v140
    v_swap_b32 v133, v141
    v_swap_b32 v134, v142
    v_swap_b32 v135, v143
L_nosw_4:
    v_mul_f32 v96, s68, v32
    v_mul_f32 v97, s68, v33
    v_mul_f32 v98, s68, v34
    v_mul_f32 v99, s68, v35
    v_mul_f32 v100, s68, v36
    v_mul_f32 v101, s68, v37
    v_mul_f32 v102, s68, v38
    v_mul_f32 v103, s68, v39
    v_mul_f32 v104, s68, v40
    v_mul_f32 v105, s68, v41
    v_mul_f32 v106, s68, v42
    v_mul_f32 v107, s68, v43
    v_mul_f32 v108, s68, v44
    v_mul_f32 v109, s68, v45
    v_mul_f32 v110, s68, v46
    v_mul_f32 v111, s68, v47
    v_exp_f32 v96, v96 clamp
    v_exp_f32 v97, v97 clamp
    v_exp_f32 v98, v98 clamp
    v_exp_f32 v99, v99 clamp
    v_exp_f32 v100, v100 clamp
    v_exp_f32 v101, v101 clamp
    v_exp_f32 v102, v102 clamp
    v_exp_f32 v103, v103 clamp
    v_exp_f32 v104, v104 clamp
    v_exp_f32 v105, v105 clamp
    v_exp_f32 v106, v106 clamp
    v_exp_f32 v107, v107 clamp
    v_exp_f32 v108, v108 clamp
    v_exp_f32 v109, v109 clamp
    v_exp_f32 v110, v110 clamp
    v_exp_f32 v111, v111 clamp
    v_max_f32 v32, 0, v32
    v_max_f32 v33, 0, v33
    v_max_f32 v34, 0, v34
    v_max_f32 v35, 0, v35
    v_max_f32 v36, 0, v36
    v_max_f32 v37, 0, v37
    v_max_f32 v38, 0, v38
    v_max_f32 v39, 0, v39
    v_max_f32 v40, 0, v40
    v_max_f32 v41, 0, v41
    v_max_f32 v42, 0, v42
    v_max_f32 v43, 0, v43
    v_max_f32 v44, 0, v44
    v_max_f32 v45, 0, v45
    v_max_f32 v46, 0, v46
    v_max_f32 v47, 0, v47
    v_add_f32 v96, s69, v96
    v_add_f32 v97, s69, v97
    v_add_f32 v98, s69, v98
    v_add_f32 v99, s69, v99
    v_add_f32 v100, s69, v100
    v_add_f32 v101, s69, v101
    v_add_f32 v102, s69, v102
    v_add_f32 v103, s69, v103
    v_add_f32 v104, s69, v104
    v_add_f32 v105, s69, v105
    v_add_f32 v106, s69, v106
    v_add_f32 v107, s69, v107
    v_add_f32 v108, s69, v108
    v_add_f32 v109, s69, v109
    v_add_f32 v110, s69, v110
    v_add_f32 v111, s69, v111
    v_add_f32 v32, v32, v96
    v_add_f32 v33, v33, v97
    v_add_f32 v34, v34, v98
    v_add_f32 v35, v35, v99
    v_add_f32 v36, v36, v100
    v_add_f32 v37, v37, v101
    v_add_f32 v38, v38, v102
    v_add_f32 v39, v39, v103
    v_add_f32 v40, v40, v104
    v_add_f32 v41, v41, v105
    v_add_f32 v42, v42, v106
    v_add_f32 v43, v43, v107
    v_add_f32 v44, v44, v108
    v_add_f32 v45, v45, v109
    v_add_f32 v46, v46, v110
    v_add_f32 v47, v47, v111
    v_cvt_pk_bf16_f32 v112, v32, v33
    v_cvt_pk_bf16_f32 v113, v34, v35
    v_cvt_pk_bf16_f32 v114, v36, v37
    v_cvt_pk_bf16_f32 v115, v38, v39
    v_cvt_pk_bf16_f32 v116, v40, v41
    v_cvt_pk_bf16_f32 v117, v42, v43
    v_cvt_pk_bf16_f32 v118, v44, v45
    v_cvt_pk_bf16_f32 v119, v46, v47
    v_mfma_f32_16x16x32_bf16 v[148:151], v[112:115], v[136:139], 0
    v_mfma_f32_16x16x32_bf16 v[144:147], v[112:115], v[128:131], 0
    v_mfma_f32_16x16x32_bf16 v[160:163], v[112:115], v[168:171], 0
    v_mfma_f32_16x16x32_bf16 v[148:151], v[116:119], v[140:143], v[148:151]
    v_mfma_f32_16x16x32_bf16 v[144:147], v[116:119], v[132:135], v[144:147]
    v_mfma_f32_16x16x32_bf16 v[160:163], v[116:119], v[168:171], v[160:163]
    v_mul_f32 v96, s68, v48
    v_mul_f32 v97, s68, v49
    v_mul_f32 v98, s68, v50
    v_mul_f32 v99, s68, v51
    v_mul_f32 v100, s68, v52
    v_mul_f32 v101, s68, v53
    v_mul_f32 v102, s68, v54
    v_mul_f32 v103, s68, v55
    v_mul_f32 v104, s68, v56
    v_mul_f32 v105, s68, v57
    v_mul_f32 v106, s68, v58
    v_mul_f32 v107, s68, v59
    v_mul_f32 v108, s68, v60
    v_mul_f32 v109, s68, v61
    v_mul_f32 v110, s68, v62
    v_mul_f32 v111, s68, v63
    v_exp_f32 v96, v96 clamp
    v_exp_f32 v97, v97 clamp
    v_exp_f32 v98, v98 clamp
    v_exp_f32 v99, v99 clamp
    v_exp_f32 v100, v100 clamp
    v_exp_f32 v101, v101 clamp
    v_exp_f32 v102, v102 clamp
    v_exp_f32 v103, v103 clamp
    v_exp_f32 v104, v104 clamp
    v_exp_f32 v105, v105 clamp
    v_exp_f32 v106, v106 clamp
    v_exp_f32 v107, v107 clamp
    v_exp_f32 v108, v108 clamp
    v_exp_f32 v109, v109 clamp
    v_exp_f32 v110, v110 clamp
    v_exp_f32 v111, v111 clamp
    v_max_f32 v48, 0, v48
    v_max_f32 v49, 0, v49
    v_max_f32 v50, 0, v50
    v_max_f32 v51, 0, v51
    v_max_f32 v52, 0, v52
    v_max_f32 v53, 0, v53
    v_max_f32 v54, 0, v54
    v_max_f32 v55, 0, v55
    v_max_f32 v56, 0, v56
    v_max_f32 v57, 0, v57
    v_max_f32 v58, 0, v58
    v_max_f32 v59, 0, v59
    v_max_f32 v60, 0, v60
    v_max_f32 v61, 0, v61
    v_max_f32 v62, 0, v62
    v_max_f32 v63, 0, v63
    v_add_f32 v96, s69, v96
    v_add_f32 v97, s69, v97
    v_add_f32 v98, s69, v98
    v_add_f32 v99, s69, v99
    v_add_f32 v100, s69, v100
    v_add_f32 v101, s69, v101
    v_add_f32 v102, s69, v102
    v_add_f32 v103, s69, v103
    v_add_f32 v104, s69, v104
    v_add_f32 v105, s69, v105
    v_add_f32 v106, s69, v106
    v_add_f32 v107, s69, v107
    v_add_f32 v108, s69, v108
    v_add_f32 v109, s69, v109
    v_add_f32 v110, s69, v110
    v_add_f32 v111, s69, v111
    v_add_f32 v48, v48, v96
    v_add_f32 v49, v49, v97
    v_add_f32 v50, v50, v98
    v_add_f32 v51, v51, v99
    v_add_f32 v52, v52, v100
    v_add_f32 v53, v53, v101
    v_add_f32 v54, v54, v102
    v_add_f32 v55, v55, v103
    v_add_f32 v56, v56, v104
    v_add_f32 v57, v57, v105
    v_add_f32 v58, v58, v106
    v_add_f32 v59, v59, v107
    v_add_f32 v60, v60, v108
    v_add_f32 v61, v61, v109
    v_add_f32 v62, v62, v110
    v_add_f32 v63, v63, v111
    v_cvt_pk_bf16_f32 v120, v48, v49
    v_cvt_pk_bf16_f32 v121, v50, v51
    v_cvt_pk_bf16_f32 v122, v52, v53
    v_cvt_pk_bf16_f32 v123, v54, v55
    v_cvt_pk_bf16_f32 v124, v56, v57
    v_cvt_pk_bf16_f32 v125, v58, v59
    v_cvt_pk_bf16_f32 v126, v60, v61
    v_cvt_pk_bf16_f32 v127, v62, v63
    v_mfma_f32_16x16x32_bf16 v[156:159], v[120:123], v[136:139], 0
    v_mfma_f32_16x16x32_bf16 v[152:155], v[120:123], v[128:131], 0
    v_mfma_f32_16x16x32_bf16 v[164:167], v[120:123], v[168:171], 0
    v_mfma_f32_16x16x32_bf16 v[156:159], v[124:127], v[140:143], v[156:159]
    v_mfma_f32_16x16x32_bf16 v[152:155], v[124:127], v[132:135], v[152:155]
    v_mfma_f32_16x16x32_bf16 v[164:167], v[124:127], v[168:171], v[164:167]
    s_lshl_b32 s42, s3, 10
    s_add_u32 s42, s42, 155648
    v_lshlrev_b32 v189, 4, v180
    v_add_u32 v189, s42, v189
    v_xor_b32 v190, 1024, v189
    s_lshl_b32 s42, s3, 7
    s_add_u32 s42, s42, 159744
    v_lshrrev_b32 v191, 4, v180
    v_lshlrev_b32 v191, 5, v191
    v_add_u32 v191, s42, v191
    s_lshl_b32 s42, s3, 2
    s_add_u32 s42, s42, 160256
    v_mov_b32 v192, s42
    v_cvt_pk_bf16_f32 v172, v148, v149
    v_cvt_pk_bf16_f32 v173, v150, v151
    v_cvt_pk_bf16_f32 v174, v156, v157
    v_cvt_pk_bf16_f32 v175, v158, v159
    ds_write_b128 v189, v[172:175]
    s_mov_b32 exec_lo, 0x00010001
    s_mov_b32 exec_hi, 0x00010001
    ds_write_b128 v191, v[160:163]
    ds_write_b128 v191, v[164:167] offset:16
    s_mov_b64 exec, -1
    ds_write_b32 v192, v181 offset:0
    v_xor_b32 v192, 4, v192
    v_xor_b32 v191, 128, v191
    s_mov_b32 s57, 1048576
L_lw_5:
    ds_read_b32 v96, v192 offset:0
    s_waitcnt lgkmcnt(0)
    v_cmp_ne_u32 vcc, s56, v96
    s_cbranch_vccz L_lwd_6
    s_sub_u32 s57, s57, 1
    s_cmp_lg_u32 s57, 0
    s_cbranch_scc1 L_lw_5
L_lwd_6:
    ds_read_b128 v[96:99], v190
    ds_read_b128 v[100:103], v191
    ds_read_b128 v[104:107], v191 offset:16
    s_lshl_b32 s42, s58, 1
    s_add_u32 s42, s42, s59
    s_lshl_b32 s42, s42, 4
    s_add_u32 s43, s42, s40
    s_lshl_b32 s44, s43, 10
    s_add_u32 s44, s44, 1048576
    s_lshl_b32 s45, s43, 6
    s_add_u32 s45, s45, 2097152
    s_lshl_b32 s43, s43, 2
    s_add_u32 s43, s43, 4096
    v_lshlrev_b32 v189, 4, v180
    v_lshrrev_b32 v191, 4, v180
    v_lshlrev_b32 v191, 4, v191
    s_waitcnt lgkmcnt(2)
    v_mfma_f32_16x16x32_bf16 v[144:147], v[184:187], v[96:99], v[144:147]
    v_mfma_f32_16x16x32_bf16 v[152:155], v[182:185], v[96:99], v[152:155]
    s_waitcnt lgkmcnt(0)
    v_add_f32 v160, v160, v100
    v_add_f32 v161, v161, v101
    v_add_f32 v162, v162, v102
    v_add_f32 v163, v163, v103
    v_add_f32 v164, v164, v104
    v_add_f32 v165, v165, v105
    v_add_f32 v166, v166, v106
    v_add_f32 v167, v167, v107
    v_cvt_pk_bf16_f32 v194, v160, v161
    v_cvt_pk_bf16_f32 v195, v162, v163
    v_cvt_pk_bf16_f32 v196, v164, v165
    v_cvt_pk_bf16_f32 v197, v166, v167
    v_cvt_pk_bf16_f32 v172, v144, v145
    v_cvt_pk_bf16_f32 v173, v146, v147
    v_cvt_pk_bf16_f32 v174, v152, v153
    v_cvt_pk_bf16_f32 v175, v154, v155
    buffer_store_dwordx4 v[172:175], v189, s[32:35], s44 offen sc1
    s_mov_b32 exec_lo, 0x00010001
    s_mov_b32 exec_hi, 0x00010001
    buffer_store_dwordx4 v[194:197], v191, s[32:35], s45 offen sc1
    s_mov_b64 exec, -1
    s_waitcnt vmcnt(0)
    v_mov_b32 v206, 1
    v_mov_b32 v207, 160576
    s_mov_b64 exec, 1
    ds_add_rtn_u32 v207, v207, v206
    s_waitcnt lgkmcnt(0)
    v_readfirstlane_b32 s72, v207
    s_mov_b64 exec, -1
    s_cmp_lg_u32 s72, 3
    s_cbranch_scc1 L_wa_7
    s_lshl_b32 s73, s41, 5
    s_add_u32 s73, s73, s40
    s_lshl_b32 s73, s73, 2
    s_add_u32 s73, s73, 24576
    s_mov_b64 exec, 1
    buffer_store_dword v181, v188, s[32:35], s73 offen sc1
    s_mov_b64 exec, -1
L_wa_7:
    v_mul_f32 v112, s68, v0
    v_mul_f32 v113, s68, v1
    v_mul_f32 v114, s68, v2
    v_mul_f32 v115, s68, v3
    v_mul_f32 v116, s68, v4
    v_mul_f32 v117, s68, v5
    v_mul_f32 v118, s68, v6
    v_mul_f32 v119, s68, v7
    v_mul_f32 v120, s68, v8
    v_mul_f32 v121, s68, v9
    v_mul_f32 v122, s68, v10
    v_mul_f32 v123, s68, v11
    v_mul_f32 v124, s68, v12
    v_mul_f32 v125, s68, v13
    v_mul_f32 v126, s68, v14
    v_mul_f32 v127, s68, v15
    v_exp_f32 v112, v112 clamp
    v_exp_f32 v113, v113 clamp
    v_exp_f32 v114, v114 clamp
    v_exp_f32 v115, v115 clamp
    v_exp_f32 v116, v116 clamp
    v_exp_f32 v117, v117 clamp
    v_exp_f32 v118, v118 clamp
    v_exp_f32 v119, v119 clamp
    v_exp_f32 v120, v120 clamp
    v_exp_f32 v121, v121 clamp
    v_exp_f32 v122, v122 clamp
    v_exp_f32 v123, v123 clamp
    v_exp_f32 v124, v124 clamp
    v_exp_f32 v125, v125 clamp
    v_exp_f32 v126, v126 clamp
    v_exp_f32 v127, v127 clamp
    v_max_f32 v0, 0, v0
    v_max_f32 v1, 0, v1
    v_max_f32 v2, 0, v2
    v_max_f32 v3, 0, v3
    v_max_f32 v4, 0, v4
    v_max_f32 v5, 0, v5
    v_max_f32 v6, 0, v6
    v_max_f32 v7, 0, v7
    v_max_f32 v8, 0, v8
    v_max_f32 v9, 0, v9
    v_max_f32 v10, 0, v10
    v_max_f32 v11, 0, v11
    v_max_f32 v12, 0, v12
    v_max_f32 v13, 0, v13
    v_max_f32 v14, 0, v14
    v_max_f32 v15, 0, v15
    v_add_f32 v112, s69, v112
    v_add_f32 v113, s69, v113
    v_add_f32 v114, s69, v114
    v_add_f32 v115, s69, v115
    v_add_f32 v116, s69, v116
    v_add_f32 v117, s69, v117
    v_add_f32 v118, s69, v118
    v_add_f32 v119, s69, v119
    v_add_f32 v120, s69, v120
    v_add_f32 v121, s69, v121
    v_add_f32 v122, s69, v122
    v_add_f32 v123, s69, v123
    v_add_f32 v124, s69, v124
    v_add_f32 v125, s69, v125
    v_add_f32 v126, s69, v126
    v_add_f32 v127, s69, v127
    v_add_f32 v0, v0, v112
    v_add_f32 v1, v1, v113
    v_add_f32 v2, v2, v114
    v_add_f32 v3, v3, v115
    v_add_f32 v4, v4, v116
    v_add_f32 v5, v5, v117
    v_add_f32 v6, v6, v118
    v_add_f32 v7, v7, v119
    v_add_f32 v8, v8, v120
    v_add_f32 v9, v9, v121
    v_add_f32 v10, v10, v122
    v_add_f32 v11, v11, v123
    v_add_f32 v12, v12, v124
    v_add_f32 v13, v13, v125
    v_add_f32 v14, v14, v126
    v_add_f32 v15, v15, v127
    v_mul_f32 v112, s68, v16
    v_mul_f32 v113, s68, v17
    v_mul_f32 v114, s68, v18
    v_mul_f32 v115, s68, v19
    v_mul_f32 v116, s68, v20
    v_mul_f32 v117, s68, v21
    v_mul_f32 v118, s68, v22
    v_mul_f32 v119, s68, v23
    v_mul_f32 v120, s68, v24
    v_mul_f32 v121, s68, v25
    v_mul_f32 v122, s68, v26
    v_mul_f32 v123, s68, v27
    v_mul_f32 v124, s68, v28
    v_mul_f32 v125, s68, v29
    v_mul_f32 v126, s68, v30
    v_mul_f32 v127, s68, v31
    v_exp_f32 v112, v112 clamp
    v_exp_f32 v113, v113 clamp
    v_exp_f32 v114, v114 clamp
    v_exp_f32 v115, v115 clamp
    v_exp_f32 v116, v116 clamp
    v_exp_f32 v117, v117 clamp
    v_exp_f32 v118, v118 clamp
    v_exp_f32 v119, v119 clamp
    v_exp_f32 v120, v120 clamp
    v_exp_f32 v121, v121 clamp
    v_exp_f32 v122, v122 clamp
    v_exp_f32 v123, v123 clamp
    v_exp_f32 v124, v124 clamp
    v_exp_f32 v125, v125 clamp
    v_exp_f32 v126, v126 clamp
    v_exp_f32 v127, v127 clamp
    v_max_f32 v16, 0, v16
    v_max_f32 v17, 0, v17
    v_max_f32 v18, 0, v18
    v_max_f32 v19, 0, v19
    v_max_f32 v20, 0, v20
    v_max_f32 v21, 0, v21
    v_max_f32 v22, 0, v22
    v_max_f32 v23, 0, v23
    v_max_f32 v24, 0, v24
    v_max_f32 v25, 0, v25
    v_max_f32 v26, 0, v26
    v_max_f32 v27, 0, v27
    v_max_f32 v28, 0, v28
    v_max_f32 v29, 0, v29
    v_max_f32 v30, 0, v30
    v_max_f32 v31, 0, v31
    v_add_f32 v112, s69, v112
    v_add_f32 v113, s69, v113
    v_add_f32 v114, s69, v114
    v_add_f32 v115, s69, v115
    v_add_f32 v116, s69, v116
    v_add_f32 v117, s69, v117
    v_add_f32 v118, s69, v118
    v_add_f32 v119, s69, v119
    v_add_f32 v120, s69, v120
    v_add_f32 v121, s69, v121
    v_add_f32 v122, s69, v122
    v_add_f32 v123, s69, v123
    v_add_f32 v124, s69, v124
    v_add_f32 v125, s69, v125
    v_add_f32 v126, s69, v126
    v_add_f32 v127, s69, v127
    v_add_f32 v16, v16, v112
    v_add_f32 v17, v17, v113
    v_add_f32 v18, v18, v114
    v_add_f32 v19, v19, v115
    v_add_f32 v20, v20, v116
    v_add_f32 v21, v21, v117
    v_add_f32 v22, v22, v118
    v_add_f32 v23, v23, v119
    v_add_f32 v24, v24, v120
    v_add_f32 v25, v25, v121
    v_add_f32 v26, v26, v122
    v_add_f32 v27, v27, v123
    v_add_f32 v28, v28, v124
    v_add_f32 v29, v29, v125
    v_add_f32 v30, v30, v126
    v_add_f32 v31, v31, v127
    v_cvt_pk_bf16_f32 v96, v0, v1
    v_cvt_pk_bf16_f32 v97, v2, v3
    v_cvt_pk_bf16_f32 v98, v16, v17
    v_cvt_pk_bf16_f32 v99, v18, v19
    v_cvt_pk_bf16_f32 v100, v4, v5
    v_cvt_pk_bf16_f32 v101, v6, v7
    v_cvt_pk_bf16_f32 v102, v20, v21
    v_cvt_pk_bf16_f32 v103, v22, v23
    v_cvt_pk_bf16_f32 v104, v8, v9
    v_cvt_pk_bf16_f32 v105, v10, v11
    v_cvt_pk_bf16_f32 v106, v24, v25
    v_cvt_pk_bf16_f32 v107, v26, v27
    v_cvt_pk_bf16_f32 v108, v12, v13
    v_cvt_pk_bf16_f32 v109, v14, v15
    v_cvt_pk_bf16_f32 v110, v28, v29
    v_cvt_pk_bf16_f32 v111, v30, v31
    v_and_b32 v190, 31, v180
    v_lshlrev_b32 v190, 2, v190
    s_lshl_b32 s42, s58, 7
    s_add_u32 s42, s42, 4096
    s_lshl_b32 s43, s58, 1
    s_add_u32 s43, s43, s59
    s_lshl_b32 s44, s43, 14
    s_add_u32 s44, s44, 1048576
    s_lshl_b32 s45, s43, 10
    s_add_u32 s45, s45, 2097152
    v_and_b32 v191, 15, v180
    v_lshlrev_b32 v191, 6, v191
    v_lshrrev_b32 v192, 4, v180
    v_lshl_add_u32 v191, v192, 4, v191
    v_mov_b32 v207, 160580
    s_cmp_lg_u32 s72, 3
    s_cbranch_scc1 L_ww_8
    s_lshl_b32 s73, s41, 7
    s_add_u32 s73, s73, 24576
    v_lshlrev_b32 v208, 2, v180
    s_mov_b64 exec, 0xffff
    s_mov_b32 s57, 1048576
L_poll_12:
    buffer_load_dword v206, v208, s[32:35], s73 offen sc1
    s_waitcnt vmcnt(0)
    v_cmp_ne_u32 vcc, s56, v206
    s_cbranch_vccz L_polld_13
    s_sub_u32 s57, s57, 1
    s_cmp_lg_u32 s57, 0
    s_cbranch_scc1 L_poll_12
L_polld_13:
L_wr_10:
    s_mov_b64 exec, 1
    ds_write_b32 v207, v181
    s_mov_b64 exec, -1
    s_branch L_wd_9
L_ww_8:
    s_mov_b32 s57, 1048576
L_lw_14:
    ds_read_b32 v206, v207 offset:0
    s_waitcnt lgkmcnt(0)
    v_cmp_ne_u32 vcc, s56, v206
    s_cbranch_vccz L_lwd_15
    s_sub_u32 s57, s57, 1
    s_cmp_lg_u32 s57, 0
    s_cbranch_scc1 L_lw_14
L_lwd_15:
L_wd_9:
    buffer_load_dwordx4 v[194:197], v191, s[32:35], s45 offen sc1
    buffer_load_dwordx4 v[112:115], v189, s[32:35], s44 offen offset:0 sc1
    buffer_load_dwordx4 v[116:119], v189, s[32:35], s44 offen offset:1024 sc1
    buffer_load_dwordx4 v[120:123], v189, s[32:35], s44 offen offset:2048 sc1
    buffer_load_dwordx4 v[124:127], v189, s[32:35], s44 offen offset:3072 sc1
    s_add_u32 s44, s44, 4096
    buffer_load_dwordx4 v[128:131], v189, s[32:35], s44 offen offset:0 sc1
    buffer_load_dwordx4 v[132:135], v189, s[32:35], s44 offen offset:1024 sc1
    buffer_load_dwordx4 v[136:139], v189, s[32:35], s44 offen offset:2048 sc1
    buffer_load_dwordx4 v[140:143], v189, s[32:35], s44 offen offset:3072 sc1
    s_add_u32 s44, s44, 4096
    buffer_load_dwordx4 v[144:147], v189, s[32:35], s44 offen offset:0 sc1
    buffer_load_dwordx4 v[148:151], v189, s[32:35], s44 offen offset:1024 sc1
    buffer_load_dwordx4 v[152:155], v189, s[32:35], s44 offen offset:2048 sc1
    buffer_load_dwordx4 v[156:159], v189, s[32:35], s44 offen offset:3072 sc1
    s_add_u32 s44, s44, 4096
    buffer_load_dwordx4 v[160:163], v189, s[32:35], s44 offen offset:0 sc1
    buffer_load_dwordx4 v[164:167], v189, s[32:35], s44 offen offset:1024 sc1
    buffer_load_dwordx4 v[168:171], v189, s[32:35], s44 offen offset:2048 sc1
    buffer_load_dwordx4 v[172:175], v189, s[32:35], s44 offen offset:3072 sc1
    s_waitcnt vmcnt(16)
    v_mfma_f32_16x16x32_bf16 v[8:11], v[184:187], v[194:197], 0
    v_mfma_f32_16x16x32_bf16 v[12:15], v[182:185], v[194:197], 0
    s_waitcnt vmcnt(15)
    v_mfma_f32_16x16x32_bf16 v[0:3], v[184:187], v[112:115], 0
    v_mfma_f32_16x16x32_bf16 v[4:7], v[182:185], v[112:115], 0
    s_waitcnt vmcnt(14)
    v_mfma_f32_16x16x32_bf16 v[0:3], v[184:187], v[116:119], v[0:3]
    v_mfma_f32_16x16x32_bf16 v[4:7], v[182:185], v[116:119], v[4:7]
    s_nop 0
    v_add_f32_dpp v8, v8, v8 row_ror:8 row_mask:0xf bank_mask:0xf
    v_add_f32_dpp v9, v9, v9 row_ror:8 row_mask:0xf bank_mask:0xf
    v_add_f32_dpp v10, v10, v10 row_ror:8 row_mask:0xf bank_mask:0xf
    v_add_f32_dpp v11, v11, v11 row_ror:8 row_mask:0xf bank_mask:0xf
    v_add_f32_dpp v12, v12, v12 row_ror:8 row_mask:0xf bank_mask:0xf
    v_add_f32_dpp v13, v13, v13 row_ror:8 row_mask:0xf bank_mask:0xf
    v_add_f32_dpp v14, v14, v14 row_ror:8 row_mask:0xf bank_mask:0xf
    v_add_f32_dpp v15, v15, v15 row_ror:8 row_mask:0xf bank_mask:0xf
    v_add_f32_dpp v8, v8, v8 row_ror:4 row_mask:0xf bank_mask:0xf
    v_add_f32_dpp v9, v9, v9 row_ror:4 row_mask:0xf bank_mask:0xf
    v_add_f32_dpp v10, v10, v10 row_ror:4 row_mask:0xf bank_mask:0xf
    v_add_f32_dpp v11, v11, v11 row_ror:4 row_mask:0xf bank_mask:0xf
    v_add_f32_dpp v12, v12, v12 row_ror:4 row_mask:0xf bank_mask:0xf
    v_add_f32_dpp v13, v13, v13 row_ror:4 row_mask:0xf bank_mask:0xf
    v_add_f32_dpp v14, v14, v14 row_ror:4 row_mask:0xf bank_mask:0xf
    v_add_f32_dpp v15, v15, v15 row_ror:4 row_mask:0xf bank_mask:0xf
    v_add_f32_dpp v8, v8, v8 row_ror:2 row_mask:0xf bank_mask:0xf
    v_add_f32_dpp v9, v9, v9 row_ror:2 row_mask:0xf bank_mask:0xf
    v_add_f32_dpp v10, v10, v10 row_ror:2 row_mask:0xf bank_mask:0xf
    v_add_f32_dpp v11, v11, v11 row_ror:2 row_mask:0xf bank_mask:0xf
    v_add_f32_dpp v12, v12, v12 row_ror:2 row_mask:0xf bank_mask:0xf
    v_add_f32_dpp v13, v13, v13 row_ror:2 row_mask:0xf bank_mask:0xf
    v_add_f32_dpp v14, v14, v14 row_ror:2 row_mask:0xf bank_mask:0xf
    v_add_f32_dpp v15, v15, v15 row_ror:2 row_mask:0xf bank_mask:0xf
    v_add_f32_dpp v8, v8, v8 row_ror:1 row_mask:0xf bank_mask:0xf
    v_add_f32_dpp v9, v9, v9 row_ror:1 row_mask:0xf bank_mask:0xf
    v_add_f32_dpp v10, v10, v10 row_ror:1 row_mask:0xf bank_mask:0xf
    v_add_f32_dpp v11, v11, v11 row_ror:1 row_mask:0xf bank_mask:0xf
    v_add_f32_dpp v12, v12, v12 row_ror:1 row_mask:0xf bank_mask:0xf
    v_add_f32_dpp v13, v13, v13 row_ror:1 row_mask:0xf bank_mask:0xf
    v_add_f32_dpp v14, v14, v14 row_ror:1 row_mask:0xf bank_mask:0xf
    v_add_f32_dpp v15, v15, v15 row_ror:1 row_mask:0xf bank_mask:0xf
    v_cvt_pk_bf16_f32 v16, v8, v9
    v_cvt_pk_bf16_f32 v17, v10, v11
    v_cvt_pk_bf16_f32 v18, v12, v13
    v_cvt_pk_bf16_f32 v19, v14, v15
    s_waitcnt vmcnt(13)
    v_mfma_f32_16x16x32_bf16 v[0:3], v[184:187], v[120:123], v[0:3]
    v_mfma_f32_16x16x32_bf16 v[4:7], v[182:185], v[120:123], v[4:7]
    s_waitcnt vmcnt(12)
    v_mfma_f32_16x16x32_bf16 v[0:3], v[184:187], v[124:127], v[0:3]
    v_mfma_f32_16x16x32_bf16 v[4:7], v[182:185], v[124:127], v[4:7]
    s_waitcnt vmcnt(11)
    v_mfma_f32_16x16x32_bf16 v[0:3], v[184:187], v[128:131], v[0:3]
    v_mfma_f32_16x16x32_bf16 v[4:7], v[182:185], v[128:131], v[4:7]
    s_waitcnt vmcnt(10)
    v_mfma_f32_16x16x32_bf16 v[0:3], v[184:187], v[132:135], v[0:3]
    v_mfma_f32_16x16x32_bf16 v[4:7], v[182:185], v[132:135], v[4:7]
    s_waitcnt vmcnt(9)
    v_mfma_f32_16x16x32_bf16 v[0:3], v[184:187], v[136:139], v[0:3]
    v_mfma_f32_16x16x32_bf16 v[4:7], v[182:185], v[136:139], v[4:7]
    s_waitcnt vmcnt(8)
    v_mfma_f32_16x16x32_bf16 v[0:3], v[184:187], v[140:143], v[0:3]
    v_mfma_f32_16x16x32_bf16 v[4:7], v[182:185], v[140:143], v[4:7]
    s_waitcnt vmcnt(7)
    v_mfma_f32_16x16x32_bf16 v[0:3], v[184:187], v[144:147], v[0:3]
    v_mfma_f32_16x16x32_bf16 v[4:7], v[182:185], v[144:147], v[4:7]
    s_waitcnt vmcnt(6)
    v_mfma_f32_16x16x32_bf16 v[0:3], v[184:187], v[148:151], v[0:3]
    v_mfma_f32_16x16x32_bf16 v[4:7], v[182:185], v[148:151], v[4:7]
    s_waitcnt vmcnt(5)
    v_mfma_f32_16x16x32_bf16 v[0:3], v[184:187], v[152:155], v[0:3]
    v_mfma_f32_16x16x32_bf16 v[4:7], v[182:185], v[152:155], v[4:7]
    s_waitcnt vmcnt(4)
    v_mfma_f32_16x16x32_bf16 v[0:3], v[184:187], v[156:159], v[0:3]
    v_mfma_f32_16x16x32_bf16 v[4:7], v[182:185], v[156:159], v[4:7]
    s_waitcnt vmcnt(3)
    v_mfma_f32_16x16x32_bf16 v[0:3], v[184:187], v[160:163], v[0:3]
    v_mfma_f32_16x16x32_bf16 v[4:7], v[182:185], v[160:163], v[4:7]
    s_waitcnt vmcnt(2)
    v_mfma_f32_16x16x32_bf16 v[0:3], v[184:187], v[164:167], v[0:3]
    v_mfma_f32_16x16x32_bf16 v[4:7], v[182:185], v[164:167], v[4:7]
    s_waitcnt vmcnt(1)
    v_mfma_f32_16x16x32_bf16 v[0:3], v[184:187], v[168:171], v[0:3]
    v_mfma_f32_16x16x32_bf16 v[4:7], v[182:185], v[168:171], v[4:7]
    s_waitcnt vmcnt(0)
    v_mfma_f32_16x16x32_bf16 v[0:3], v[184:187], v[172:175], v[0:3]
    v_mfma_f32_16x16x32_bf16 v[4:7], v[182:185], v[172:175], v[4:7]
    s_nop 6
    v_cvt_pk_bf16_f32 v172, v0, v1
    v_cvt_pk_bf16_f32 v173, v2, v3
    v_cvt_pk_bf16_f32 v174, v4, v5
    v_cvt_pk_bf16_f32 v175, v6, v7
    s_lshl_b32 s42, s3, 10
    s_add_u32 s42, s42, 155648
    v_add_u32 v190, s42, v189
    s_lshl_b32 s42, s3, 2
    s_add_u32 s42, s42, 160256
    v_mov_b32 v192, s42
    ds_write_b128 v190, v[172:175]
    ds_write_b32 v192, v181 offset:16
    v_xor_b32 v192, 4, v192
    v_and_b32 v190, 4294966271, v190
    s_lshl_b32 s42, s40, 1
    s_add_u32 s42, s42, s59
    s_lshl_b32 s43, s42, 7
    s_add_u32 s43, s43, s58
    s_lshl_b32 s44, s43, 10
    s_add_u32 s44, s44, 4194304
    s_lshl_b32 s45, s42, 5
    s_add_u32 s45, s45, s58
    s_lshl_b32 s45, s45, 2
    s_add_u32 s45, s45, 8192
    s_mov_b32 s57, 1048576
L_lw_16:
    ds_read_b32 v28, v192 offset:16
    s_waitcnt lgkmcnt(0)
    v_cmp_ne_u32 vcc, s56, v28
    s_cbranch_vccz L_lwd_17
    s_sub_u32 s57, s57, 1
    s_cmp_lg_u32 s57, 0
    s_cbranch_scc1 L_lw_16
L_lwd_17:
    ds_read_b128 v[20:23], v190
    ds_read_b128 v[24:27], v190 offset:1024
    v_mfma_f32_16x16x32_bf16 v[120:123], v[16:19], v[96:99], 0
    v_mfma_f32_16x16x32_bf16 v[132:135], v[16:19], v[100:103], 0
    v_mfma_f32_16x16x32_bf16 v[144:147], v[16:19], v[104:107], 0
    v_mfma_f32_16x16x32_bf16 v[156:159], v[16:19], v[108:111], 0
    s_waitcnt lgkmcnt(0)
    v_mfma_f32_16x16x32_bf16 v[112:115], v[20:23], v[96:99], 0
    v_mfma_f32_16x16x32_bf16 v[116:119], v[24:27], v[96:99], 0
    v_mfma_f32_16x16x32_bf16 v[124:127], v[20:23], v[100:103], 0
    v_mfma_f32_16x16x32_bf16 v[128:131], v[24:27], v[100:103], 0
    v_mfma_f32_16x16x32_bf16 v[136:139], v[20:23], v[104:107], 0
    v_mfma_f32_16x16x32_bf16 v[140:143], v[24:27], v[104:107], 0
    v_mfma_f32_16x16x32_bf16 v[148:151], v[20:23], v[108:111], 0
    v_mfma_f32_16x16x32_bf16 v[152:155], v[24:27], v[108:111], 0
    v_add_f32 v120, s69, v120
    v_add_f32 v132, s69, v132
    v_add_f32 v144, s69, v144
    v_add_f32 v156, s69, v156
    v_rcp_f32 v120, v120
    v_rcp_f32 v132, v132
    v_rcp_f32 v144, v144
    v_rcp_f32 v156, v156
    v_mul_f32 v112, v112, v120
    v_mul_f32 v113, v113, v120
    v_mul_f32 v114, v114, v120
    v_mul_f32 v115, v115, v120
    v_mul_f32 v116, v116, v120
    v_mul_f32 v117, v117, v120
    v_mul_f32 v118, v118, v120
    v_mul_f32 v119, v119, v120
    v_cvt_pk_bf16_f32 v32, v112, v113
    v_cvt_pk_bf16_f32 v33, v114, v115
    v_cvt_pk_bf16_f32 v34, v116, v117
    v_cvt_pk_bf16_f32 v35, v118, v119
    buffer_store_dwordx4 v[32:35], v189, s[32:35], s44 offen sc1
    s_add_u32 s44, s44, 32768
    v_mul_f32 v124, v124, v132
    v_mul_f32 v125, v125, v132
    v_mul_f32 v126, v126, v132
    v_mul_f32 v127, v127, v132
    v_mul_f32 v128, v128, v132
    v_mul_f32 v129, v129, v132
    v_mul_f32 v130, v130, v132
    v_mul_f32 v131, v131, v132
    v_cvt_pk_bf16_f32 v36, v124, v125
    v_cvt_pk_bf16_f32 v37, v126, v127
    v_cvt_pk_bf16_f32 v38, v128, v129
    v_cvt_pk_bf16_f32 v39, v130, v131
    buffer_store_dwordx4 v[36:39], v189, s[32:35], s44 offen sc1
    s_add_u32 s44, s44, 32768
    v_mul_f32 v136, v136, v144
    v_mul_f32 v137, v137, v144
    v_mul_f32 v138, v138, v144
    v_mul_f32 v139, v139, v144
    v_mul_f32 v140, v140, v144
    v_mul_f32 v141, v141, v144
    v_mul_f32 v142, v142, v144
    v_mul_f32 v143, v143, v144
    v_cvt_pk_bf16_f32 v40, v136, v137
    v_cvt_pk_bf16_f32 v41, v138, v139
    v_cvt_pk_bf16_f32 v42, v140, v141
    v_cvt_pk_bf16_f32 v43, v142, v143
    buffer_store_dwordx4 v[40:43], v189, s[32:35], s44 offen sc1
    s_add_u32 s44, s44, 32768
    v_mul_f32 v148, v148, v156
    v_mul_f32 v149, v149, v156
    v_mul_f32 v150, v150, v156
    v_mul_f32 v151, v151, v156
    v_mul_f32 v152, v152, v156
    v_mul_f32 v153, v153, v156
    v_mul_f32 v154, v154, v156
    v_mul_f32 v155, v155, v156
    v_cvt_pk_bf16_f32 v44, v148, v149
    v_cvt_pk_bf16_f32 v45, v150, v151
    v_cvt_pk_bf16_f32 v46, v152, v153
    v_cvt_pk_bf16_f32 v47, v154, v155
    buffer_store_dwordx4 v[44:47], v189, s[32:35], s44 offen sc1
    s_waitcnt vmcnt(0)
    v_mov_b32 v206, 1
    v_mov_b32 v207, 160584
    s_mov_b64 exec, 1
    ds_add_rtn_u32 v207, v207, v206
    s_waitcnt lgkmcnt(0)
    v_readfirstlane_b32 s72, v207
    s_mov_b64 exec, -1
    s_cmp_lg_u32 s72, 3
    s_cbranch_scc1 L_wa_18
    s_lshl_b32 s73, s40, 5
    s_add_u32 s73, s73, s41
    s_lshl_b32 s73, s73, 2
    s_add_u32 s73, s73, 28672
    s_mov_b64 exec, 1
    buffer_store_dword v181, v188, s[32:35], s73 offen sc1
    s_mov_b64 exec, -1
L_wa_18:
    s_and_b32 s42, s2, 7
    s_lshr_b32 s43, s2, 3
    s_and_b32 s70, s42, 3
    s_lshl_b32 s70, s70, 2
    s_and_b32 s44, s43, 3
    s_add_u32 s70, s70, s44
    s_lshr_b32 s71, s42, 2
    s_lshl_b32 s71, s71, 3
    s_lshr_b32 s44, s43, 2
    s_add_u32 s71, s71, s44
    s_mov_b32 s64, s16
    s_mov_b32 s65, s17
    s_mov_b32 s66, 8388608
    s_mov_b32 s67, 0x00020000
    s_lshl_b32 s42, s70, 1
    s_lshr_b32 s43, s3, 1
    s_add_u32 s42, s42, s43
    s_lshl_b32 s42, s42, 7
    s_add_u32 s42, s42, 8192
    v_and_b32 v203, 31, v180
    v_lshlrev_b32 v203, 2, v203
    s_lshl_b32 s44, s70, 3
    s_lshl_b32 s43, s3, 1
    s_add_u32 s44, s44, s43
    s_lshl_b32 s44, s44, 15
    s_add_u32 s44, s44, 4194304
    s_add_u32 s45, s44, 32768
    v_lshlrev_b32 v202, 4, v180
    v_lshrrev_b32 v198, 2, v180
    v_bfe_u32 v199, v180, 3, 2
    v_lshlrev_b32 v199, 5, v199
    v_lshl_add_u32 v198, v198, 7, v199
    v_and_b32 v199, 3, v180
    v_lshl_add_u32 v198, v199, 3, v198
    v_xor_b32 v199, 32, v198
    v_xor_b32 v200, 64, v198
    v_xor_b32 v201, 96, v198
    v_and_b32 v204, 7, v180
    v_lshlrev_b32 v204, 12, v204
    v_bfe_u32 v205, v180, 3, 1
    v_lshl_add_u32 v204, v205, 6, v204
    v_bfe_u32 v205, v180, 4, 1
    v_lshl_add_u32 v204, v205, 5, v204
    v_lshrrev_b32 v205, 5, v180
    v_lshl_add_u32 v204, v205, 4, v204
    v_mov_b32 v207, 160588
    s_cmp_lg_u32 s72, 3
    s_cbranch_scc1 L_ww_19
    s_lshl_b32 s73, s70, 7
    s_add_u32 s73, s73, 28672
    v_lshlrev_b32 v208, 2, v180
    s_mov_b64 exec, 0xffff
    s_mov_b32 s57, 1048576
L_poll_23:
    buffer_load_dword v206, v208, s[32:35], s73 offen sc1
    s_waitcnt vmcnt(0)
    v_cmp_ne_u32 vcc, s56, v206
    s_cbranch_vccz L_polld_24
    s_sub_u32 s57, s57, 1
    s_cmp_lg_u32 s57, 0
    s_cbranch_scc1 L_poll_23
L_polld_24:
L_wr_21:
    s_mov_b64 exec, 1
    ds_write_b32 v207, v181
    s_mov_b64 exec, -1
    s_branch L_wd_20
L_ww_19:
    s_mov_b32 s57, 1048576
L_lw_25:
    ds_read_b32 v206, v207 offset:0
    s_waitcnt lgkmcnt(0)
    v_cmp_ne_u32 vcc, s56, v206
    s_cbranch_vccz L_lwd_26
    s_sub_u32 s57, s57, 1
    s_cmp_lg_u32 s57, 0
    s_cbranch_scc1 L_lw_25
L_lwd_26:
L_wd_20:
    buffer_load_dwordx4 v[64:67], v202, s[32:35], s44 offen offset:0 sc1
    buffer_load_dwordx4 v[68:71], v202, s[32:35], s45 offen offset:0 sc1
    buffer_load_dwordx4 v[72:75], v202, s[32:35], s44 offen offset:1024 sc1
    buffer_load_dwordx4 v[76:79], v202, s[32:35], s45 offen offset:1024 sc1
    buffer_load_dwordx4 v[80:83], v202, s[32:35], s44 offen offset:2048 sc1
    buffer_load_dwordx4 v[84:87], v202, s[32:35], s45 offen offset:2048 sc1
    buffer_load_dwordx4 v[88:91], v202, s[32:35], s44 offen offset:3072 sc1
    buffer_load_dwordx4 v[92:95], v202, s[32:35], s45 offen offset:3072 sc1
    s_add_u32 s44, s44, 4096
    s_add_u32 s45, s45, 4096
    buffer_load_dwordx4 v[96:99], v202, s[32:35], s44 offen offset:0 sc1
    buffer_load_dwordx4 v[100:103], v202, s[32:35], s45 offen offset:0 sc1
    buffer_load_dwordx4 v[104:107], v202, s[32:35], s44 offen offset:1024 sc1
    buffer_load_dwordx4 v[108:111], v202, s[32:35], s45 offen offset:1024 sc1
    buffer_load_dwordx4 v[112:115], v202, s[32:35], s44 offen offset:2048 sc1
    buffer_load_dwordx4 v[116:119], v202, s[32:35], s45 offen offset:2048 sc1
    buffer_load_dwordx4 v[120:123], v202, s[32:35], s44 offen offset:3072 sc1
    buffer_load_dwordx4 v[124:127], v202, s[32:35], s45 offen offset:3072 sc1
    s_add_u32 s44, s44, 4096
    s_add_u32 s45, s45, 4096
    buffer_load_dwordx4 v[128:131], v202, s[32:35], s44 offen offset:0 sc1
    buffer_load_dwordx4 v[132:135], v202, s[32:35], s45 offen offset:0 sc1
    buffer_load_dwordx4 v[136:139], v202, s[32:35], s44 offen offset:1024 sc1
    buffer_load_dwordx4 v[140:143], v202, s[32:35], s45 offen offset:1024 sc1
    buffer_load_dwordx4 v[144:147], v202, s[32:35], s44 offen offset:2048 sc1
    buffer_load_dwordx4 v[148:151], v202, s[32:35], s45 offen offset:2048 sc1
    buffer_load_dwordx4 v[152:155], v202, s[32:35], s44 offen offset:3072 sc1
    buffer_load_dwordx4 v[156:159], v202, s[32:35], s45 offen offset:3072 sc1
    s_add_u32 s44, s44, 4096
    s_add_u32 s45, s45, 4096
    buffer_load_dwordx4 v[160:163], v202, s[32:35], s44 offen offset:0 sc1
    buffer_load_dwordx4 v[164:167], v202, s[32:35], s45 offen offset:0 sc1
    buffer_load_dwordx4 v[168:171], v202, s[32:35], s44 offen offset:1024 sc1
    buffer_load_dwordx4 v[172:175], v202, s[32:35], s45 offen offset:1024 sc1
    v_and_b32 v205, 3, v180
    v_lshlrev_b32 v205, 2, v205
    v_add_u32 v205, 160256, v205
    s_mov_b32 s57, 1048576
L_lw_27:
    ds_read_b32 v28, v205 offset:32
    s_waitcnt lgkmcnt(0)
    v_cmp_ne_u32 vcc, s56, v28
    s_cbranch_vccz L_lwd_28
    s_sub_u32 s57, s57, 1
    s_cmp_lg_u32 s57, 0
    s_cbranch_scc1 L_lw_27
L_lwd_28:
    ds_read_b64_tr_b16 v[32:33], v198 offset:0
    ds_read_b64_tr_b16 v[34:35], v198 offset:2048
    ds_read_b64_tr_b16 v[36:37], v199 offset:0
    ds_read_b64_tr_b16 v[38:39], v199 offset:2048
    ds_read_b64_tr_b16 v[40:41], v200 offset:0
    ds_read_b64_tr_b16 v[42:43], v200 offset:2048
    ds_read_b64_tr_b16 v[44:45], v201 offset:0
    ds_read_b64_tr_b16 v[46:47], v201 offset:2048
    s_waitcnt lgkmcnt(6)
    s_waitcnt vmcnt(27)
    v_mfma_f32_16x16x32_bf16 v[0:3], v[32:35], v[64:67], 0
    s_waitcnt vmcnt(26)
    v_mfma_f32_16x16x32_bf16 v[16:19], v[32:35], v[68:71], 0
    ds_read_b64_tr_b16 v[48:49], v198 offset:4096
    ds_read_b64_tr_b16 v[50:51], v198 offset:6144
    s_waitcnt lgkmcnt(6)
    v_mfma_f32_16x16x32_bf16 v[4:7], v[36:39], v[64:67], 0
    v_mfma_f32_16x16x32_bf16 v[20:23], v[36:39], v[68:71], 0
    ds_read_b64_tr_b16 v[52:53], v199 offset:4096
    ds_read_b64_tr_b16 v[54:55], v199 offset:6144
    s_waitcnt lgkmcnt(6)
    v_mfma_f32_16x16x32_bf16 v[8:11], v[40:43], v[64:67], 0
    v_mfma_f32_16x16x32_bf16 v[24:27], v[40:43], v[68:71], 0
    ds_read_b64_tr_b16 v[56:57], v200 offset:4096
    ds_read_b64_tr_b16 v[58:59], v200 offset:6144
    s_waitcnt lgkmcnt(6)
    v_mfma_f32_16x16x32_bf16 v[12:15], v[44:47], v[64:67], 0
    v_mfma_f32_16x16x32_bf16 v[28:31], v[44:47], v[68:71], 0
    ds_read_b64_tr_b16 v[60:61], v201 offset:4096
    ds_read_b64_tr_b16 v[62:63], v201 offset:6144
    buffer_load_dwordx4 v[64:67], v202, s[32:35], s44 offen offset:2048 sc1
    buffer_load_dwordx4 v[68:71], v202, s[32:35], s45 offen offset:2048 sc1
    s_waitcnt lgkmcnt(6)
    s_waitcnt vmcnt(27)
    v_mfma_f32_16x16x32_bf16 v[0:3], v[48:51], v[72:75], v[0:3]
    s_waitcnt vmcnt(26)
    v_mfma_f32_16x16x32_bf16 v[16:19], v[48:51], v[76:79], v[16:19]
    ds_read_b64_tr_b16 v[32:33], v198 offset:8192
    ds_read_b64_tr_b16 v[34:35], v198 offset:10240
    s_waitcnt lgkmcnt(6)
    v_mfma_f32_16x16x32_bf16 v[4:7], v[52:55], v[72:75], v[4:7]
    v_mfma_f32_16x16x32_bf16 v[20:23], v[52:55], v[76:79], v[20:23]
    ds_read_b64_tr_b16 v[36:37], v199 offset:8192
    ds_read_b64_tr_b16 v[38:39], v199 offset:10240
    s_waitcnt lgkmcnt(6)
    v_mfma_f32_16x16x32_bf16 v[8:11], v[56:59], v[72:75], v[8:11]
    v_mfma_f32_16x16x32_bf16 v[24:27], v[56:59], v[76:79], v[24:27]
    ds_read_b64_tr_b16 v[40:41], v200 offset:8192
    ds_read_b64_tr_b16 v[42:43], v200 offset:10240
    s_waitcnt lgkmcnt(6)
    v_mfma_f32_16x16x32_bf16 v[12:15], v[60:63], v[72:75], v[12:15]
    v_mfma_f32_16x16x32_bf16 v[28:31], v[60:63], v[76:79], v[28:31]
    ds_read_b64_tr_b16 v[44:45], v201 offset:8192
    ds_read_b64_tr_b16 v[46:47], v201 offset:10240
    buffer_load_dwordx4 v[72:75], v202, s[32:35], s44 offen offset:3072 sc1
    buffer_load_dwordx4 v[76:79], v202, s[32:35], s45 offen offset:3072 sc1
    s_waitcnt lgkmcnt(6)
    s_waitcnt vmcnt(27)
    v_mfma_f32_16x16x32_bf16 v[0:3], v[32:35], v[80:83], v[0:3]
    s_waitcnt vmcnt(26)
    v_mfma_f32_16x16x32_bf16 v[16:19], v[32:35], v[84:87], v[16:19]
    ds_read_b64_tr_b16 v[48:49], v198 offset:12288
    ds_read_b64_tr_b16 v[50:51], v198 offset:14336
    s_waitcnt lgkmcnt(6)
    v_mfma_f32_16x16x32_bf16 v[4:7], v[36:39], v[80:83], v[4:7]
    v_mfma_f32_16x16x32_bf16 v[20:23], v[36:39], v[84:87], v[20:23]
    ds_read_b64_tr_b16 v[52:53], v199 offset:12288
    ds_read_b64_tr_b16 v[54:55], v199 offset:14336
    s_waitcnt lgkmcnt(6)
    v_mfma_f32_16x16x32_bf16 v[8:11], v[40:43], v[80:83], v[8:11]
    v_mfma_f32_16x16x32_bf16 v[24:27], v[40:43], v[84:87], v[24:27]
    ds_read_b64_tr_b16 v[56:57], v200 offset:12288
    ds_read_b64_tr_b16 v[58:59], v200 offset:14336
    s_waitcnt lgkmcnt(6)
    v_mfma_f32_16x16x32_bf16 v[12:15], v[44:47], v[80:83], v[12:15]
    v_mfma_f32_16x16x32_bf16 v[28:31], v[44:47], v[84:87], v[28:31]
    ds_read_b64_tr_b16 v[60:61], v201 offset:12288
    ds_read_b64_tr_b16 v[62:63], v201 offset:14336
    s_add_u32 s44, s44, 4096
    s_add_u32 s45, s45, 4096
    buffer_load_dwordx4 v[80:83], v202, s[32:35], s44 offen offset:0 sc1
    buffer_load_dwordx4 v[84:87], v202, s[32:35], s45 offen offset:0 sc1
    s_waitcnt lgkmcnt(6)
    s_waitcnt vmcnt(27)
    v_mfma_f32_16x16x32_bf16 v[0:3], v[48:51], v[88:91], v[0:3]
    s_waitcnt vmcnt(26)
    v_mfma_f32_16x16x32_bf16 v[16:19], v[48:51], v[92:95], v[16:19]
    ds_read_b64_tr_b16 v[32:33], v198 offset:16384
    ds_read_b64_tr_b16 v[34:35], v198 offset:18432
    s_waitcnt lgkmcnt(6)
    v_mfma_f32_16x16x32_bf16 v[4:7], v[52:55], v[88:91], v[4:7]
    v_mfma_f32_16x16x32_bf16 v[20:23], v[52:55], v[92:95], v[20:23]
    ds_read_b64_tr_b16 v[36:37], v199 offset:16384
    ds_read_b64_tr_b16 v[38:39], v199 offset:18432
    s_waitcnt lgkmcnt(6)
    v_mfma_f32_16x16x32_bf16 v[8:11], v[56:59], v[88:91], v[8:11]
    v_mfma_f32_16x16x32_bf16 v[24:27], v[56:59], v[92:95], v[24:27]
    ds_read_b64_tr_b16 v[40:41], v200 offset:16384
    ds_read_b64_tr_b16 v[42:43], v200 offset:18432
    s_waitcnt lgkmcnt(6)
    v_mfma_f32_16x16x32_bf16 v[12:15], v[60:63], v[88:91], v[12:15]
    v_mfma_f32_16x16x32_bf16 v[28:31], v[60:63], v[92:95], v[28:31]
    ds_read_b64_tr_b16 v[44:45], v201 offset:16384
    ds_read_b64_tr_b16 v[46:47], v201 offset:18432
    buffer_load_dwordx4 v[88:91], v202, s[32:35], s44 offen offset:1024 sc1
    buffer_load_dwordx4 v[92:95], v202, s[32:35], s45 offen offset:1024 sc1
    s_waitcnt lgkmcnt(6)
    s_waitcnt vmcnt(27)
    v_mfma_f32_16x16x32_bf16 v[0:3], v[32:35], v[96:99], v[0:3]
    s_waitcnt vmcnt(26)
    v_mfma_f32_16x16x32_bf16 v[16:19], v[32:35], v[100:103], v[16:19]
    ds_read_b64_tr_b16 v[48:49], v198 offset:20480
    ds_read_b64_tr_b16 v[50:51], v198 offset:22528
    s_waitcnt lgkmcnt(6)
    v_mfma_f32_16x16x32_bf16 v[4:7], v[36:39], v[96:99], v[4:7]
    v_mfma_f32_16x16x32_bf16 v[20:23], v[36:39], v[100:103], v[20:23]
    ds_read_b64_tr_b16 v[52:53], v199 offset:20480
    ds_read_b64_tr_b16 v[54:55], v199 offset:22528
    s_waitcnt lgkmcnt(6)
    v_mfma_f32_16x16x32_bf16 v[8:11], v[40:43], v[96:99], v[8:11]
    v_mfma_f32_16x16x32_bf16 v[24:27], v[40:43], v[100:103], v[24:27]
    ds_read_b64_tr_b16 v[56:57], v200 offset:20480
    ds_read_b64_tr_b16 v[58:59], v200 offset:22528
    s_waitcnt lgkmcnt(6)
    v_mfma_f32_16x16x32_bf16 v[12:15], v[44:47], v[96:99], v[12:15]
    v_mfma_f32_16x16x32_bf16 v[28:31], v[44:47], v[100:103], v[28:31]
    ds_read_b64_tr_b16 v[60:61], v201 offset:20480
    ds_read_b64_tr_b16 v[62:63], v201 offset:22528
    buffer_load_dwordx4 v[96:99], v202, s[32:35], s44 offen offset:2048 sc1
    buffer_load_dwordx4 v[100:103], v202, s[32:35], s45 offen offset:2048 sc1
    s_waitcnt lgkmcnt(6)
    s_waitcnt vmcnt(27)
    v_mfma_f32_16x16x32_bf16 v[0:3], v[48:51], v[104:107], v[0:3]
    s_waitcnt vmcnt(26)
    v_mfma_f32_16x16x32_bf16 v[16:19], v[48:51], v[108:111], v[16:19]
    ds_read_b64_tr_b16 v[32:33], v198 offset:24576
    ds_read_b64_tr_b16 v[34:35], v198 offset:26624
    s_waitcnt lgkmcnt(6)
    v_mfma_f32_16x16x32_bf16 v[4:7], v[52:55], v[104:107], v[4:7]
    v_mfma_f32_16x16x32_bf16 v[20:23], v[52:55], v[108:111], v[20:23]
    ds_read_b64_tr_b16 v[36:37], v199 offset:24576
    ds_read_b64_tr_b16 v[38:39], v199 offset:26624
    s_waitcnt lgkmcnt(6)
    v_mfma_f32_16x16x32_bf16 v[8:11], v[56:59], v[104:107], v[8:11]
    v_mfma_f32_16x16x32_bf16 v[24:27], v[56:59], v[108:111], v[24:27]
    ds_read_b64_tr_b16 v[40:41], v200 offset:24576
    ds_read_b64_tr_b16 v[42:43], v200 offset:26624
    s_waitcnt lgkmcnt(6)
    v_mfma_f32_16x16x32_bf16 v[12:15], v[60:63], v[104:107], v[12:15]
    v_mfma_f32_16x16x32_bf16 v[28:31], v[60:63], v[108:111], v[28:31]
    ds_read_b64_tr_b16 v[44:45], v201 offset:24576
    ds_read_b64_tr_b16 v[46:47], v201 offset:26624
    buffer_load_dwordx4 v[104:107], v202, s[32:35], s44 offen offset:3072 sc1
    buffer_load_dwordx4 v[108:111], v202, s[32:35], s45 offen offset:3072 sc1
    s_waitcnt lgkmcnt(6)
    s_waitcnt vmcnt(27)
    v_mfma_f32_16x16x32_bf16 v[0:3], v[32:35], v[112:115], v[0:3]
    s_waitcnt vmcnt(26)
    v_mfma_f32_16x16x32_bf16 v[16:19], v[32:35], v[116:119], v[16:19]
    ds_read_b64_tr_b16 v[48:49], v198 offset:28672
    ds_read_b64_tr_b16 v[50:51], v198 offset:30720
    s_waitcnt lgkmcnt(6)
    v_mfma_f32_16x16x32_bf16 v[4:7], v[36:39], v[112:115], v[4:7]
    v_mfma_f32_16x16x32_bf16 v[20:23], v[36:39], v[116:119], v[20:23]
    ds_read_b64_tr_b16 v[52:53], v199 offset:28672
    ds_read_b64_tr_b16 v[54:55], v199 offset:30720
    s_waitcnt lgkmcnt(6)
    v_mfma_f32_16x16x32_bf16 v[8:11], v[40:43], v[112:115], v[8:11]
    v_mfma_f32_16x16x32_bf16 v[24:27], v[40:43], v[116:119], v[24:27]
    ds_read_b64_tr_b16 v[56:57], v200 offset:28672
    ds_read_b64_tr_b16 v[58:59], v200 offset:30720
    s_waitcnt lgkmcnt(6)
    v_mfma_f32_16x16x32_bf16 v[12:15], v[44:47], v[112:115], v[12:15]
    v_mfma_f32_16x16x32_bf16 v[28:31], v[44:47], v[116:119], v[28:31]
    ds_read_b64_tr_b16 v[60:61], v201 offset:28672
    ds_read_b64_tr_b16 v[62:63], v201 offset:30720
    s_add_u32 s44, s44, 4096
    s_add_u32 s45, s45, 4096
    buffer_load_dwordx4 v[112:115], v202, s[32:35], s44 offen offset:0 sc1
    buffer_load_dwordx4 v[116:119], v202, s[32:35], s45 offen offset:0 sc1
    s_waitcnt lgkmcnt(6)
    s_waitcnt vmcnt(27)
    v_mfma_f32_16x16x32_bf16 v[0:3], v[48:51], v[120:123], v[0:3]
    s_waitcnt vmcnt(26)
    v_mfma_f32_16x16x32_bf16 v[16:19], v[48:51], v[124:127], v[16:19]
    ds_read_b64_tr_b16 v[32:33], v198 offset:32768
    ds_read_b64_tr_b16 v[34:35], v198 offset:34816
    s_waitcnt lgkmcnt(6)
    v_mfma_f32_16x16x32_bf16 v[4:7], v[52:55], v[120:123], v[4:7]
    v_mfma_f32_16x16x32_bf16 v[20:23], v[52:55], v[124:127], v[20:23]
    ds_read_b64_tr_b16 v[36:37], v199 offset:32768
    ds_read_b64_tr_b16 v[38:39], v199 offset:34816
    s_waitcnt lgkmcnt(6)
    v_mfma_f32_16x16x32_bf16 v[8:11], v[56:59], v[120:123], v[8:11]
    v_mfma_f32_16x16x32_bf16 v[24:27], v[56:59], v[124:127], v[24:27]
    ds_read_b64_tr_b16 v[40:41], v200 offset:32768
    ds_read_b64_tr_b16 v[42:43], v200 offset:34816
    s_waitcnt lgkmcnt(6)
    v_mfma_f32_16x16x32_bf16 v[12:15], v[60:63], v[120:123], v[12:15]
    v_mfma_f32_16x16x32_bf16 v[28:31], v[60:63], v[124:127], v[28:31]
    ds_read_b64_tr_b16 v[44:45], v201 offset:32768
    ds_read_b64_tr_b16 v[46:47], v201 offset:34816
    buffer_load_dwordx4 v[120:123], v202, s[32:35], s44 offen offset:1024 sc1
    buffer_load_dwordx4 v[124:127], v202, s[32:35], s45 offen offset:1024 sc1
    s_waitcnt lgkmcnt(6)
    s_waitcnt vmcnt(27)
    v_mfma_f32_16x16x32_bf16 v[0:3], v[32:35], v[128:131], v[0:3]
    s_waitcnt vmcnt(26)
    v_mfma_f32_16x16x32_bf16 v[16:19], v[32:35], v[132:135], v[16:19]
    ds_read_b64_tr_b16 v[48:49], v198 offset:36864
    ds_read_b64_tr_b16 v[50:51], v198 offset:38912
    s_waitcnt lgkmcnt(6)
    v_mfma_f32_16x16x32_bf16 v[4:7], v[36:39], v[128:131], v[4:7]
    v_mfma_f32_16x16x32_bf16 v[20:23], v[36:39], v[132:135], v[20:23]
    ds_read_b64_tr_b16 v[52:53], v199 offset:36864
    ds_read_b64_tr_b16 v[54:55], v199 offset:38912
    s_waitcnt lgkmcnt(6)
    v_mfma_f32_16x16x32_bf16 v[8:11], v[40:43], v[128:131], v[8:11]
    v_mfma_f32_16x16x32_bf16 v[24:27], v[40:43], v[132:135], v[24:27]
    ds_read_b64_tr_b16 v[56:57], v200 offset:36864
    ds_read_b64_tr_b16 v[58:59], v200 offset:38912
    s_waitcnt lgkmcnt(6)
    v_mfma_f32_16x16x32_bf16 v[12:15], v[44:47], v[128:131], v[12:15]
    v_mfma_f32_16x16x32_bf16 v[28:31], v[44:47], v[132:135], v[28:31]
    ds_read_b64_tr_b16 v[60:61], v201 offset:36864
    ds_read_b64_tr_b16 v[62:63], v201 offset:38912
    buffer_load_dwordx4 v[128:131], v202, s[32:35], s44 offen offset:2048 sc1
    buffer_load_dwordx4 v[132:135], v202, s[32:35], s45 offen offset:2048 sc1
    s_waitcnt lgkmcnt(6)
    s_waitcnt vmcnt(27)
    v_mfma_f32_16x16x32_bf16 v[0:3], v[48:51], v[136:139], v[0:3]
    s_waitcnt vmcnt(26)
    v_mfma_f32_16x16x32_bf16 v[16:19], v[48:51], v[140:143], v[16:19]
    ds_read_b64_tr_b16 v[32:33], v198 offset:40960
    ds_read_b64_tr_b16 v[34:35], v198 offset:43008
    s_waitcnt lgkmcnt(6)
    v_mfma_f32_16x16x32_bf16 v[4:7], v[52:55], v[136:139], v[4:7]
    v_mfma_f32_16x16x32_bf16 v[20:23], v[52:55], v[140:143], v[20:23]
    ds_read_b64_tr_b16 v[36:37], v199 offset:40960
    ds_read_b64_tr_b16 v[38:39], v199 offset:43008
    s_waitcnt lgkmcnt(6)
    v_mfma_f32_16x16x32_bf16 v[8:11], v[56:59], v[136:139], v[8:11]
    v_mfma_f32_16x16x32_bf16 v[24:27], v[56:59], v[140:143], v[24:27]
    ds_read_b64_tr_b16 v[40:41], v200 offset:40960
    ds_read_b64_tr_b16 v[42:43], v200 offset:43008
    s_waitcnt lgkmcnt(6)
    v_mfma_f32_16x16x32_bf16 v[12:15], v[60:63], v[136:139], v[12:15]
    v_mfma_f32_16x16x32_bf16 v[28:31], v[60:63], v[140:143], v[28:31]
    ds_read_b64_tr_b16 v[44:45], v201 offset:40960
    ds_read_b64_tr_b16 v[46:47], v201 offset:43008
    buffer_load_dwordx4 v[136:139], v202, s[32:35], s44 offen offset:3072 sc1
    buffer_load_dwordx4 v[140:143], v202, s[32:35], s45 offen offset:3072 sc1
    s_waitcnt lgkmcnt(6)
    s_waitcnt vmcnt(27)
    v_mfma_f32_16x16x32_bf16 v[0:3], v[32:35], v[144:147], v[0:3]
    s_waitcnt vmcnt(26)
    v_mfma_f32_16x16x32_bf16 v[16:19], v[32:35], v[148:151], v[16:19]
    ds_read_b64_tr_b16 v[48:49], v198 offset:45056
    ds_read_b64_tr_b16 v[50:51], v198 offset:47104
    s_waitcnt lgkmcnt(6)
    v_mfma_f32_16x16x32_bf16 v[4:7], v[36:39], v[144:147], v[4:7]
    v_mfma_f32_16x16x32_bf16 v[20:23], v[36:39], v[148:151], v[20:23]
    ds_read_b64_tr_b16 v[52:53], v199 offset:45056
    ds_read_b64_tr_b16 v[54:55], v199 offset:47104
    s_waitcnt lgkmcnt(6)
    v_mfma_f32_16x16x32_bf16 v[8:11], v[40:43], v[144:147], v[8:11]
    v_mfma_f32_16x16x32_bf16 v[24:27], v[40:43], v[148:151], v[24:27]
    ds_read_b64_tr_b16 v[56:57], v200 offset:45056
    ds_read_b64_tr_b16 v[58:59], v200 offset:47104
    s_waitcnt lgkmcnt(6)
    v_mfma_f32_16x16x32_bf16 v[12:15], v[44:47], v[144:147], v[12:15]
    v_mfma_f32_16x16x32_bf16 v[28:31], v[44:47], v[148:151], v[28:31]
    ds_read_b64_tr_b16 v[60:61], v201 offset:45056
    ds_read_b64_tr_b16 v[62:63], v201 offset:47104
    s_add_u32 s44, s44, 4096
    s_add_u32 s45, s45, 4096
    buffer_load_dwordx4 v[144:147], v202, s[32:35], s44 offen offset:0 sc1
    buffer_load_dwordx4 v[148:151], v202, s[32:35], s45 offen offset:0 sc1
    s_waitcnt lgkmcnt(6)
    s_waitcnt vmcnt(27)
    v_mfma_f32_16x16x32_bf16 v[0:3], v[48:51], v[152:155], v[0:3]
    s_waitcnt vmcnt(26)
    v_mfma_f32_16x16x32_bf16 v[16:19], v[48:51], v[156:159], v[16:19]
    ds_read_b64_tr_b16 v[32:33], v198 offset:49152
    ds_read_b64_tr_b16 v[34:35], v198 offset:51200
    s_waitcnt lgkmcnt(6)
    v_mfma_f32_16x16x32_bf16 v[4:7], v[52:55], v[152:155], v[4:7]
    v_mfma_f32_16x16x32_bf16 v[20:23], v[52:55], v[156:159], v[20:23]
    ds_read_b64_tr_b16 v[36:37], v199 offset:49152
    ds_read_b64_tr_b16 v[38:39], v199 offset:51200
    s_waitcnt lgkmcnt(6)
    v_mfma_f32_16x16x32_bf16 v[8:11], v[56:59], v[152:155], v[8:11]
    v_mfma_f32_16x16x32_bf16 v[24:27], v[56:59], v[156:159], v[24:27]
    ds_read_b64_tr_b16 v[40:41], v200 offset:49152
    ds_read_b64_tr_b16 v[42:43], v200 offset:51200
    s_waitcnt lgkmcnt(6)
    v_mfma_f32_16x16x32_bf16 v[12:15], v[60:63], v[152:155], v[12:15]
    v_mfma_f32_16x16x32_bf16 v[28:31], v[60:63], v[156:159], v[28:31]
    ds_read_b64_tr_b16 v[44:45], v201 offset:49152
    ds_read_b64_tr_b16 v[46:47], v201 offset:51200
    buffer_load_dwordx4 v[152:155], v202, s[32:35], s44 offen offset:1024 sc1
    buffer_load_dwordx4 v[156:159], v202, s[32:35], s45 offen offset:1024 sc1
    s_waitcnt lgkmcnt(6)
    s_waitcnt vmcnt(27)
    v_mfma_f32_16x16x32_bf16 v[0:3], v[32:35], v[160:163], v[0:3]
    s_waitcnt vmcnt(26)
    v_mfma_f32_16x16x32_bf16 v[16:19], v[32:35], v[164:167], v[16:19]
    ds_read_b64_tr_b16 v[48:49], v198 offset:53248
    ds_read_b64_tr_b16 v[50:51], v198 offset:55296
    s_waitcnt lgkmcnt(6)
    v_mfma_f32_16x16x32_bf16 v[4:7], v[36:39], v[160:163], v[4:7]
    v_mfma_f32_16x16x32_bf16 v[20:23], v[36:39], v[164:167], v[20:23]
    ds_read_b64_tr_b16 v[52:53], v199 offset:53248
    ds_read_b64_tr_b16 v[54:55], v199 offset:55296
    s_waitcnt lgkmcnt(6)
    v_mfma_f32_16x16x32_bf16 v[8:11], v[40:43], v[160:163], v[8:11]
    v_mfma_f32_16x16x32_bf16 v[24:27], v[40:43], v[164:167], v[24:27]
    ds_read_b64_tr_b16 v[56:57], v200 offset:53248
    ds_read_b64_tr_b16 v[58:59], v200 offset:55296
    s_waitcnt lgkmcnt(6)
    v_mfma_f32_16x16x32_bf16 v[12:15], v[44:47], v[160:163], v[12:15]
    v_mfma_f32_16x16x32_bf16 v[28:31], v[44:47], v[164:167], v[28:31]
    ds_read_b64_tr_b16 v[60:61], v201 offset:53248
    ds_read_b64_tr_b16 v[62:63], v201 offset:55296
    buffer_load_dwordx4 v[160:163], v202, s[32:35], s44 offen offset:2048 sc1
    buffer_load_dwordx4 v[164:167], v202, s[32:35], s45 offen offset:2048 sc1
    s_waitcnt lgkmcnt(6)
    s_waitcnt vmcnt(27)
    v_mfma_f32_16x16x32_bf16 v[0:3], v[48:51], v[168:171], v[0:3]
    s_waitcnt vmcnt(26)
    v_mfma_f32_16x16x32_bf16 v[16:19], v[48:51], v[172:175], v[16:19]
    ds_read_b64_tr_b16 v[32:33], v198 offset:57344
    ds_read_b64_tr_b16 v[34:35], v198 offset:59392
    s_waitcnt lgkmcnt(6)
    v_mfma_f32_16x16x32_bf16 v[4:7], v[52:55], v[168:171], v[4:7]
    v_mfma_f32_16x16x32_bf16 v[20:23], v[52:55], v[172:175], v[20:23]
    ds_read_b64_tr_b16 v[36:37], v199 offset:57344
    ds_read_b64_tr_b16 v[38:39], v199 offset:59392
    s_waitcnt lgkmcnt(6)
    v_mfma_f32_16x16x32_bf16 v[8:11], v[56:59], v[168:171], v[8:11]
    v_mfma_f32_16x16x32_bf16 v[24:27], v[56:59], v[172:175], v[24:27]
    ds_read_b64_tr_b16 v[40:41], v200 offset:57344
    ds_read_b64_tr_b16 v[42:43], v200 offset:59392
    s_waitcnt lgkmcnt(6)
    v_mfma_f32_16x16x32_bf16 v[12:15], v[60:63], v[168:171], v[12:15]
    v_mfma_f32_16x16x32_bf16 v[28:31], v[60:63], v[172:175], v[28:31]
    ds_read_b64_tr_b16 v[44:45], v201 offset:57344
    ds_read_b64_tr_b16 v[46:47], v201 offset:59392
    buffer_load_dwordx4 v[168:171], v202, s[32:35], s44 offen offset:3072 sc1
    buffer_load_dwordx4 v[172:175], v202, s[32:35], s45 offen offset:3072 sc1
    s_waitcnt lgkmcnt(6)
    s_waitcnt vmcnt(27)
    v_mfma_f32_16x16x32_bf16 v[0:3], v[32:35], v[64:67], v[0:3]
    s_waitcnt vmcnt(26)
    v_mfma_f32_16x16x32_bf16 v[16:19], v[32:35], v[68:71], v[16:19]
    ds_read_b64_tr_b16 v[48:49], v198 offset:61440
    ds_read_b64_tr_b16 v[50:51], v198 offset:63488
    s_waitcnt lgkmcnt(6)
    v_mfma_f32_16x16x32_bf16 v[4:7], v[36:39], v[64:67], v[4:7]
    v_mfma_f32_16x16x32_bf16 v[20:23], v[36:39], v[68:71], v[20:23]
    ds_read_b64_tr_b16 v[52:53], v199 offset:61440
    ds_read_b64_tr_b16 v[54:55], v199 offset:63488
    s_waitcnt lgkmcnt(6)
    v_mfma_f32_16x16x32_bf16 v[8:11], v[40:43], v[64:67], v[8:11]
    v_mfma_f32_16x16x32_bf16 v[24:27], v[40:43], v[68:71], v[24:27]
    ds_read_b64_tr_b16 v[56:57], v200 offset:61440
    ds_read_b64_tr_b16 v[58:59], v200 offset:63488
    s_waitcnt lgkmcnt(6)
    v_mfma_f32_16x16x32_bf16 v[12:15], v[44:47], v[64:67], v[12:15]
    v_mfma_f32_16x16x32_bf16 v[28:31], v[44:47], v[68:71], v[28:31]
    ds_read_b64_tr_b16 v[60:61], v201 offset:61440
    ds_read_b64_tr_b16 v[62:63], v201 offset:63488
    s_add_u32 s44, s44, 4096
    s_add_u32 s45, s45, 4096
    buffer_load_dwordx4 v[64:67], v202, s[32:35], s44 offen offset:0 sc1
    buffer_load_dwordx4 v[68:71], v202, s[32:35], s45 offen offset:0 sc1
    s_waitcnt lgkmcnt(6)
    s_waitcnt vmcnt(27)
    v_mfma_f32_16x16x32_bf16 v[0:3], v[48:51], v[72:75], v[0:3]
    s_waitcnt vmcnt(26)
    v_mfma_f32_16x16x32_bf16 v[16:19], v[48:51], v[76:79], v[16:19]
    v_add_u32 v198, 0x10000, v198
    ds_read_b64_tr_b16 v[32:33], v198 offset:0
    ds_read_b64_tr_b16 v[34:35], v198 offset:2048
    s_waitcnt lgkmcnt(6)
    v_mfma_f32_16x16x32_bf16 v[4:7], v[52:55], v[72:75], v[4:7]
    v_mfma_f32_16x16x32_bf16 v[20:23], v[52:55], v[76:79], v[20:23]
    v_add_u32 v199, 0x10000, v199
    ds_read_b64_tr_b16 v[36:37], v199 offset:0
    ds_read_b64_tr_b16 v[38:39], v199 offset:2048
    s_waitcnt lgkmcnt(6)
    v_mfma_f32_16x16x32_bf16 v[8:11], v[56:59], v[72:75], v[8:11]
    v_mfma_f32_16x16x32_bf16 v[24:27], v[56:59], v[76:79], v[24:27]
    v_add_u32 v200, 0x10000, v200
    ds_read_b64_tr_b16 v[40:41], v200 offset:0
    ds_read_b64_tr_b16 v[42:43], v200 offset:2048
    s_waitcnt lgkmcnt(6)
    v_mfma_f32_16x16x32_bf16 v[12:15], v[60:63], v[72:75], v[12:15]
    v_mfma_f32_16x16x32_bf16 v[28:31], v[60:63], v[76:79], v[28:31]
    v_add_u32 v201, 0x10000, v201
    ds_read_b64_tr_b16 v[44:45], v201 offset:0
    ds_read_b64_tr_b16 v[46:47], v201 offset:2048
    buffer_load_dwordx4 v[72:75], v202, s[32:35], s44 offen offset:1024 sc1
    buffer_load_dwordx4 v[76:79], v202, s[32:35], s45 offen offset:1024 sc1
    s_waitcnt lgkmcnt(6)
    s_waitcnt vmcnt(27)
    v_mfma_f32_16x16x32_bf16 v[0:3], v[32:35], v[80:83], v[0:3]
    s_waitcnt vmcnt(26)
    v_mfma_f32_16x16x32_bf16 v[16:19], v[32:35], v[84:87], v[16:19]
    ds_read_b64_tr_b16 v[48:49], v198 offset:4096
    ds_read_b64_tr_b16 v[50:51], v198 offset:6144
    s_waitcnt lgkmcnt(6)
    v_mfma_f32_16x16x32_bf16 v[4:7], v[36:39], v[80:83], v[4:7]
    v_mfma_f32_16x16x32_bf16 v[20:23], v[36:39], v[84:87], v[20:23]
    ds_read_b64_tr_b16 v[52:53], v199 offset:4096
    ds_read_b64_tr_b16 v[54:55], v199 offset:6144
    s_waitcnt lgkmcnt(6)
    v_mfma_f32_16x16x32_bf16 v[8:11], v[40:43], v[80:83], v[8:11]
    v_mfma_f32_16x16x32_bf16 v[24:27], v[40:43], v[84:87], v[24:27]
    ds_read_b64_tr_b16 v[56:57], v200 offset:4096
    ds_read_b64_tr_b16 v[58:59], v200 offset:6144
    s_waitcnt lgkmcnt(6)
    v_mfma_f32_16x16x32_bf16 v[12:15], v[44:47], v[80:83], v[12:15]
    v_mfma_f32_16x16x32_bf16 v[28:31], v[44:47], v[84:87], v[28:31]
    ds_read_b64_tr_b16 v[60:61], v201 offset:4096
    ds_read_b64_tr_b16 v[62:63], v201 offset:6144
    buffer_load_dwordx4 v[80:83], v202, s[32:35], s44 offen offset:2048 sc1
    buffer_load_dwordx4 v[84:87], v202, s[32:35], s45 offen offset:2048 sc1
    s_waitcnt lgkmcnt(6)
    s_waitcnt vmcnt(27)
    v_mfma_f32_16x16x32_bf16 v[0:3], v[48:51], v[88:91], v[0:3]
    s_waitcnt vmcnt(26)
    v_mfma_f32_16x16x32_bf16 v[16:19], v[48:51], v[92:95], v[16:19]
    ds_read_b64_tr_b16 v[32:33], v198 offset:8192
    ds_read_b64_tr_b16 v[34:35], v198 offset:10240
    s_waitcnt lgkmcnt(6)
    v_mfma_f32_16x16x32_bf16 v[4:7], v[52:55], v[88:91], v[4:7]
    v_mfma_f32_16x16x32_bf16 v[20:23], v[52:55], v[92:95], v[20:23]
    ds_read_b64_tr_b16 v[36:37], v199 offset:8192
    ds_read_b64_tr_b16 v[38:39], v199 offset:10240
    s_waitcnt lgkmcnt(6)
    v_mfma_f32_16x16x32_bf16 v[8:11], v[56:59], v[88:91], v[8:11]
    v_mfma_f32_16x16x32_bf16 v[24:27], v[56:59], v[92:95], v[24:27]
    ds_read_b64_tr_b16 v[40:41], v200 offset:8192
    ds_read_b64_tr_b16 v[42:43], v200 offset:10240
    s_waitcnt lgkmcnt(6)
    v_mfma_f32_16x16x32_bf16 v[12:15], v[60:63], v[88:91], v[12:15]
    v_mfma_f32_16x16x32_bf16 v[28:31], v[60:63], v[92:95], v[28:31]
    ds_read_b64_tr_b16 v[44:45], v201 offset:8192
    ds_read_b64_tr_b16 v[46:47], v201 offset:10240
    buffer_load_dwordx4 v[88:91], v202, s[32:35], s44 offen offset:3072 sc1
    buffer_load_dwordx4 v[92:95], v202, s[32:35], s45 offen offset:3072 sc1
    s_waitcnt lgkmcnt(6)
    s_waitcnt vmcnt(27)
    v_mfma_f32_16x16x32_bf16 v[0:3], v[32:35], v[96:99], v[0:3]
    s_waitcnt vmcnt(26)
    v_mfma_f32_16x16x32_bf16 v[16:19], v[32:35], v[100:103], v[16:19]
    ds_read_b64_tr_b16 v[48:49], v198 offset:12288
    ds_read_b64_tr_b16 v[50:51], v198 offset:14336
    s_waitcnt lgkmcnt(6)
    v_mfma_f32_16x16x32_bf16 v[4:7], v[36:39], v[96:99], v[4:7]
    v_mfma_f32_16x16x32_bf16 v[20:23], v[36:39], v[100:103], v[20:23]
    ds_read_b64_tr_b16 v[52:53], v199 offset:12288
    ds_read_b64_tr_b16 v[54:55], v199 offset:14336
    s_waitcnt lgkmcnt(6)
    v_mfma_f32_16x16x32_bf16 v[8:11], v[40:43], v[96:99], v[8:11]
    v_mfma_f32_16x16x32_bf16 v[24:27], v[40:43], v[100:103], v[24:27]
    ds_read_b64_tr_b16 v[56:57], v200 offset:12288
    ds_read_b64_tr_b16 v[58:59], v200 offset:14336
    s_waitcnt lgkmcnt(6)
    v_mfma_f32_16x16x32_bf16 v[12:15], v[44:47], v[96:99], v[12:15]
    v_mfma_f32_16x16x32_bf16 v[28:31], v[44:47], v[100:103], v[28:31]
    ds_read_b64_tr_b16 v[60:61], v201 offset:12288
    ds_read_b64_tr_b16 v[62:63], v201 offset:14336
    s_waitcnt lgkmcnt(6)
    s_waitcnt vmcnt(25)
    v_mfma_f32_16x16x32_bf16 v[0:3], v[48:51], v[104:107], v[0:3]
    s_waitcnt vmcnt(24)
    v_mfma_f32_16x16x32_bf16 v[16:19], v[48:51], v[108:111], v[16:19]
    ds_read_b64_tr_b16 v[32:33], v198 offset:16384
    ds_read_b64_tr_b16 v[34:35], v198 offset:18432
    s_waitcnt lgkmcnt(6)
    v_mfma_f32_16x16x32_bf16 v[4:7], v[52:55], v[104:107], v[4:7]
    v_mfma_f32_16x16x32_bf16 v[20:23], v[52:55], v[108:111], v[20:23]
    ds_read_b64_tr_b16 v[36:37], v199 offset:16384
    ds_read_b64_tr_b16 v[38:39], v199 offset:18432
    s_waitcnt lgkmcnt(6)
    v_mfma_f32_16x16x32_bf16 v[8:11], v[56:59], v[104:107], v[8:11]
    v_mfma_f32_16x16x32_bf16 v[24:27], v[56:59], v[108:111], v[24:27]
    ds_read_b64_tr_b16 v[40:41], v200 offset:16384
    ds_read_b64_tr_b16 v[42:43], v200 offset:18432
    s_waitcnt lgkmcnt(6)
    v_mfma_f32_16x16x32_bf16 v[12:15], v[60:63], v[104:107], v[12:15]
    v_mfma_f32_16x16x32_bf16 v[28:31], v[60:63], v[108:111], v[28:31]
    ds_read_b64_tr_b16 v[44:45], v201 offset:16384
    ds_read_b64_tr_b16 v[46:47], v201 offset:18432
    s_waitcnt lgkmcnt(6)
    s_waitcnt vmcnt(23)
    v_mfma_f32_16x16x32_bf16 v[0:3], v[32:35], v[112:115], v[0:3]
    s_waitcnt vmcnt(22)
    v_mfma_f32_16x16x32_bf16 v[16:19], v[32:35], v[116:119], v[16:19]
    ds_read_b64_tr_b16 v[48:49], v198 offset:20480
    ds_read_b64_tr_b16 v[50:51], v198 offset:22528
    s_waitcnt lgkmcnt(6)
    v_mfma_f32_16x16x32_bf16 v[4:7], v[36:39], v[112:115], v[4:7]
    v_mfma_f32_16x16x32_bf16 v[20:23], v[36:39], v[116:119], v[20:23]
    ds_read_b64_tr_b16 v[52:53], v199 offset:20480
    ds_read_b64_tr_b16 v[54:55], v199 offset:22528
    s_waitcnt lgkmcnt(6)
    v_mfma_f32_16x16x32_bf16 v[8:11], v[40:43], v[112:115], v[8:11]
    v_mfma_f32_16x16x32_bf16 v[24:27], v[40:43], v[116:119], v[24:27]
    ds_read_b64_tr_b16 v[56:57], v200 offset:20480
    ds_read_b64_tr_b16 v[58:59], v200 offset:22528
    s_waitcnt lgkmcnt(6)
    v_mfma_f32_16x16x32_bf16 v[12:15], v[44:47], v[112:115], v[12:15]
    v_mfma_f32_16x16x32_bf16 v[28:31], v[44:47], v[116:119], v[28:31]
    ds_read_b64_tr_b16 v[60:61], v201 offset:20480
    ds_read_b64_tr_b16 v[62:63], v201 offset:22528
    s_waitcnt lgkmcnt(6)
    s_waitcnt vmcnt(21)
    v_mfma_f32_16x16x32_bf16 v[0:3], v[48:51], v[120:123], v[0:3]
    s_waitcnt vmcnt(20)
    v_mfma_f32_16x16x32_bf16 v[16:19], v[48:51], v[124:127], v[16:19]
    ds_read_b64_tr_b16 v[32:33], v198 offset:24576
    ds_read_b64_tr_b16 v[34:35], v198 offset:26624
    s_waitcnt lgkmcnt(6)
    v_mfma_f32_16x16x32_bf16 v[4:7], v[52:55], v[120:123], v[4:7]
    v_mfma_f32_16x16x32_bf16 v[20:23], v[52:55], v[124:127], v[20:23]
    ds_read_b64_tr_b16 v[36:37], v199 offset:24576
    ds_read_b64_tr_b16 v[38:39], v199 offset:26624
    s_waitcnt lgkmcnt(6)
    v_mfma_f32_16x16x32_bf16 v[8:11], v[56:59], v[120:123], v[8:11]
    v_mfma_f32_16x16x32_bf16 v[24:27], v[56:59], v[124:127], v[24:27]
    ds_read_b64_tr_b16 v[40:41], v200 offset:24576
    ds_read_b64_tr_b16 v[42:43], v200 offset:26624
    s_waitcnt lgkmcnt(6)
    v_mfma_f32_16x16x32_bf16 v[12:15], v[60:63], v[120:123], v[12:15]
    v_mfma_f32_16x16x32_bf16 v[28:31], v[60:63], v[124:127], v[28:31]
    ds_read_b64_tr_b16 v[44:45], v201 offset:24576
    ds_read_b64_tr_b16 v[46:47], v201 offset:26624
    s_waitcnt lgkmcnt(6)
    s_waitcnt vmcnt(19)
    v_mfma_f32_16x16x32_bf16 v[0:3], v[32:35], v[128:131], v[0:3]
    s_waitcnt vmcnt(18)
    v_mfma_f32_16x16x32_bf16 v[16:19], v[32:35], v[132:135], v[16:19]
    ds_read_b64_tr_b16 v[48:49], v198 offset:28672
    ds_read_b64_tr_b16 v[50:51], v198 offset:30720
    s_waitcnt lgkmcnt(6)
    v_mfma_f32_16x16x32_bf16 v[4:7], v[36:39], v[128:131], v[4:7]
    v_mfma_f32_16x16x32_bf16 v[20:23], v[36:39], v[132:135], v[20:23]
    ds_read_b64_tr_b16 v[52:53], v199 offset:28672
    ds_read_b64_tr_b16 v[54:55], v199 offset:30720
    s_waitcnt lgkmcnt(6)
    v_mfma_f32_16x16x32_bf16 v[8:11], v[40:43], v[128:131], v[8:11]
    v_mfma_f32_16x16x32_bf16 v[24:27], v[40:43], v[132:135], v[24:27]
    ds_read_b64_tr_b16 v[56:57], v200 offset:28672
    ds_read_b64_tr_b16 v[58:59], v200 offset:30720
    s_waitcnt lgkmcnt(6)
    v_mfma_f32_16x16x32_bf16 v[12:15], v[44:47], v[128:131], v[12:15]
    v_mfma_f32_16x16x32_bf16 v[28:31], v[44:47], v[132:135], v[28:31]
    ds_read_b64_tr_b16 v[60:61], v201 offset:28672
    ds_read_b64_tr_b16 v[62:63], v201 offset:30720
    s_waitcnt lgkmcnt(6)
    s_waitcnt vmcnt(17)
    v_mfma_f32_16x16x32_bf16 v[0:3], v[48:51], v[136:139], v[0:3]
    s_waitcnt vmcnt(16)
    v_mfma_f32_16x16x32_bf16 v[16:19], v[48:51], v[140:143], v[16:19]
    ds_read_b64_tr_b16 v[32:33], v198 offset:32768
    ds_read_b64_tr_b16 v[34:35], v198 offset:34816
    s_waitcnt lgkmcnt(6)
    v_mfma_f32_16x16x32_bf16 v[4:7], v[52:55], v[136:139], v[4:7]
    v_mfma_f32_16x16x32_bf16 v[20:23], v[52:55], v[140:143], v[20:23]
    ds_read_b64_tr_b16 v[36:37], v199 offset:32768
    ds_read_b64_tr_b16 v[38:39], v199 offset:34816
    s_waitcnt lgkmcnt(6)
    v_mfma_f32_16x16x32_bf16 v[8:11], v[56:59], v[136:139], v[8:11]
    v_mfma_f32_16x16x32_bf16 v[24:27], v[56:59], v[140:143], v[24:27]
    ds_read_b64_tr_b16 v[40:41], v200 offset:32768
    ds_read_b64_tr_b16 v[42:43], v200 offset:34816
    s_waitcnt lgkmcnt(6)
    v_mfma_f32_16x16x32_bf16 v[12:15], v[60:63], v[136:139], v[12:15]
    v_mfma_f32_16x16x32_bf16 v[28:31], v[60:63], v[140:143], v[28:31]
    ds_read_b64_tr_b16 v[44:45], v201 offset:32768
    ds_read_b64_tr_b16 v[46:47], v201 offset:34816
    s_waitcnt lgkmcnt(6)
    s_waitcnt vmcnt(15)
    v_mfma_f32_16x16x32_bf16 v[0:3], v[32:35], v[144:147], v[0:3]
    s_waitcnt vmcnt(14)
    v_mfma_f32_16x16x32_bf16 v[16:19], v[32:35], v[148:151], v[16:19]
    ds_read_b64_tr_b16 v[48:49], v198 offset:36864
    ds_read_b64_tr_b16 v[50:51], v198 offset:38912
    s_waitcnt lgkmcnt(6)
    v_mfma_f32_16x16x32_bf16 v[4:7], v[36:39], v[144:147], v[4:7]
    v_mfma_f32_16x16x32_bf16 v[20:23], v[36:39], v[148:151], v[20:23]
    ds_read_b64_tr_b16 v[52:53], v199 offset:36864
    ds_read_b64_tr_b16 v[54:55], v199 offset:38912
    s_waitcnt lgkmcnt(6)
    v_mfma_f32_16x16x32_bf16 v[8:11], v[40:43], v[144:147], v[8:11]
    v_mfma_f32_16x16x32_bf16 v[24:27], v[40:43], v[148:151], v[24:27]
    ds_read_b64_tr_b16 v[56:57], v200 offset:36864
    ds_read_b64_tr_b16 v[58:59], v200 offset:38912
    s_waitcnt lgkmcnt(6)
    v_mfma_f32_16x16x32_bf16 v[12:15], v[44:47], v[144:147], v[12:15]
    v_mfma_f32_16x16x32_bf16 v[28:31], v[44:47], v[148:151], v[28:31]
    ds_read_b64_tr_b16 v[60:61], v201 offset:36864
    ds_read_b64_tr_b16 v[62:63], v201 offset:38912
    s_waitcnt lgkmcnt(6)
    s_waitcnt vmcnt(13)
    v_mfma_f32_16x16x32_bf16 v[0:3], v[48:51], v[152:155], v[0:3]
    s_waitcnt vmcnt(12)
    v_mfma_f32_16x16x32_bf16 v[16:19], v[48:51], v[156:159], v[16:19]
    ds_read_b64_tr_b16 v[32:33], v198 offset:40960
    ds_read_b64_tr_b16 v[34:35], v198 offset:43008
    s_waitcnt lgkmcnt(6)
    v_mfma_f32_16x16x32_bf16 v[4:7], v[52:55], v[152:155], v[4:7]
    v_mfma_f32_16x16x32_bf16 v[20:23], v[52:55], v[156:159], v[20:23]
    ds_read_b64_tr_b16 v[36:37], v199 offset:40960
    ds_read_b64_tr_b16 v[38:39], v199 offset:43008
    s_waitcnt lgkmcnt(6)
    v_mfma_f32_16x16x32_bf16 v[8:11], v[56:59], v[152:155], v[8:11]
    v_mfma_f32_16x16x32_bf16 v[24:27], v[56:59], v[156:159], v[24:27]
    ds_read_b64_tr_b16 v[40:41], v200 offset:40960
    ds_read_b64_tr_b16 v[42:43], v200 offset:43008
    s_waitcnt lgkmcnt(6)
    v_mfma_f32_16x16x32_bf16 v[12:15], v[60:63], v[152:155], v[12:15]
    v_mfma_f32_16x16x32_bf16 v[28:31], v[60:63], v[156:159], v[28:31]
    ds_read_b64_tr_b16 v[44:45], v201 offset:40960
    ds_read_b64_tr_b16 v[46:47], v201 offset:43008
    s_waitcnt lgkmcnt(6)
    s_waitcnt vmcnt(11)
    v_mfma_f32_16x16x32_bf16 v[0:3], v[32:35], v[160:163], v[0:3]
    s_waitcnt vmcnt(10)
    v_mfma_f32_16x16x32_bf16 v[16:19], v[32:35], v[164:167], v[16:19]
    ds_read_b64_tr_b16 v[48:49], v198 offset:45056
    ds_read_b64_tr_b16 v[50:51], v198 offset:47104
    s_waitcnt lgkmcnt(6)
    v_mfma_f32_16x16x32_bf16 v[4:7], v[36:39], v[160:163], v[4:7]
    v_mfma_f32_16x16x32_bf16 v[20:23], v[36:39], v[164:167], v[20:23]
    ds_read_b64_tr_b16 v[52:53], v199 offset:45056
    ds_read_b64_tr_b16 v[54:55], v199 offset:47104
    s_waitcnt lgkmcnt(6)
    v_mfma_f32_16x16x32_bf16 v[8:11], v[40:43], v[160:163], v[8:11]
    v_mfma_f32_16x16x32_bf16 v[24:27], v[40:43], v[164:167], v[24:27]
    ds_read_b64_tr_b16 v[56:57], v200 offset:45056
    ds_read_b64_tr_b16 v[58:59], v200 offset:47104
    s_waitcnt lgkmcnt(6)
    v_mfma_f32_16x16x32_bf16 v[12:15], v[44:47], v[160:163], v[12:15]
    v_mfma_f32_16x16x32_bf16 v[28:31], v[44:47], v[164:167], v[28:31]
    ds_read_b64_tr_b16 v[60:61], v201 offset:45056
    ds_read_b64_tr_b16 v[62:63], v201 offset:47104
    s_waitcnt lgkmcnt(6)
    s_waitcnt vmcnt(9)
    v_mfma_f32_16x16x32_bf16 v[0:3], v[48:51], v[168:171], v[0:3]
    s_waitcnt vmcnt(8)
    v_mfma_f32_16x16x32_bf16 v[16:19], v[48:51], v[172:175], v[16:19]
    ds_read_b64_tr_b16 v[32:33], v198 offset:49152
    ds_read_b64_tr_b16 v[34:35], v198 offset:51200
    s_waitcnt lgkmcnt(6)
    v_mfma_f32_16x16x32_bf16 v[4:7], v[52:55], v[168:171], v[4:7]
    v_mfma_f32_16x16x32_bf16 v[20:23], v[52:55], v[172:175], v[20:23]
    ds_read_b64_tr_b16 v[36:37], v199 offset:49152
    ds_read_b64_tr_b16 v[38:39], v199 offset:51200
    s_waitcnt lgkmcnt(6)
    v_mfma_f32_16x16x32_bf16 v[8:11], v[56:59], v[168:171], v[8:11]
    v_mfma_f32_16x16x32_bf16 v[24:27], v[56:59], v[172:175], v[24:27]
    ds_read_b64_tr_b16 v[40:41], v200 offset:49152
    ds_read_b64_tr_b16 v[42:43], v200 offset:51200
    s_waitcnt lgkmcnt(6)
    v_mfma_f32_16x16x32_bf16 v[12:15], v[60:63], v[168:171], v[12:15]
    v_mfma_f32_16x16x32_bf16 v[28:31], v[60:63], v[172:175], v[28:31]
    ds_read_b64_tr_b16 v[44:45], v201 offset:49152
    ds_read_b64_tr_b16 v[46:47], v201 offset:51200
    s_waitcnt lgkmcnt(6)
    s_waitcnt vmcnt(7)
    v_mfma_f32_16x16x32_bf16 v[0:3], v[32:35], v[64:67], v[0:3]
    s_waitcnt vmcnt(6)
    v_mfma_f32_16x16x32_bf16 v[16:19], v[32:35], v[68:71], v[16:19]
    ds_read_b64_tr_b16 v[48:49], v198 offset:53248
    ds_read_b64_tr_b16 v[50:51], v198 offset:55296
    s_waitcnt lgkmcnt(6)
    v_mfma_f32_16x16x32_bf16 v[4:7], v[36:39], v[64:67], v[4:7]
    v_mfma_f32_16x16x32_bf16 v[20:23], v[36:39], v[68:71], v[20:23]
    ds_read_b64_tr_b16 v[52:53], v199 offset:53248
    ds_read_b64_tr_b16 v[54:55], v199 offset:55296
    s_waitcnt lgkmcnt(6)
    v_mfma_f32_16x16x32_bf16 v[8:11], v[40:43], v[64:67], v[8:11]
    v_mfma_f32_16x16x32_bf16 v[24:27], v[40:43], v[68:71], v[24:27]
    ds_read_b64_tr_b16 v[56:57], v200 offset:53248
    ds_read_b64_tr_b16 v[58:59], v200 offset:55296
    s_waitcnt lgkmcnt(6)
    v_mfma_f32_16x16x32_bf16 v[12:15], v[44:47], v[64:67], v[12:15]
    v_mfma_f32_16x16x32_bf16 v[28:31], v[44:47], v[68:71], v[28:31]
    ds_read_b64_tr_b16 v[60:61], v201 offset:53248
    ds_read_b64_tr_b16 v[62:63], v201 offset:55296
    s_waitcnt lgkmcnt(6)
    s_waitcnt vmcnt(5)
    v_mfma_f32_16x16x32_bf16 v[0:3], v[48:51], v[72:75], v[0:3]
    s_waitcnt vmcnt(4)
    v_mfma_f32_16x16x32_bf16 v[16:19], v[48:51], v[76:79], v[16:19]
    ds_read_b64_tr_b16 v[32:33], v198 offset:57344
    ds_read_b64_tr_b16 v[34:35], v198 offset:59392
    s_waitcnt lgkmcnt(6)
    v_mfma_f32_16x16x32_bf16 v[4:7], v[52:55], v[72:75], v[4:7]
    v_mfma_f32_16x16x32_bf16 v[20:23], v[52:55], v[76:79], v[20:23]
    ds_read_b64_tr_b16 v[36:37], v199 offset:57344
    ds_read_b64_tr_b16 v[38:39], v199 offset:59392
    s_waitcnt lgkmcnt(6)
    v_mfma_f32_16x16x32_bf16 v[8:11], v[56:59], v[72:75], v[8:11]
    v_mfma_f32_16x16x32_bf16 v[24:27], v[56:59], v[76:79], v[24:27]
    ds_read_b64_tr_b16 v[40:41], v200 offset:57344
    ds_read_b64_tr_b16 v[42:43], v200 offset:59392
    s_waitcnt lgkmcnt(6)
    v_mfma_f32_16x16x32_bf16 v[12:15], v[60:63], v[72:75], v[12:15]
    v_mfma_f32_16x16x32_bf16 v[28:31], v[60:63], v[76:79], v[28:31]
    ds_read_b64_tr_b16 v[44:45], v201 offset:57344
    ds_read_b64_tr_b16 v[46:47], v201 offset:59392
    s_waitcnt lgkmcnt(6)
    s_waitcnt vmcnt(3)
    v_mfma_f32_16x16x32_bf16 v[0:3], v[32:35], v[80:83], v[0:3]
    s_waitcnt vmcnt(2)
    v_mfma_f32_16x16x32_bf16 v[16:19], v[32:35], v[84:87], v[16:19]
    ds_read_b64_tr_b16 v[48:49], v198 offset:61440
    ds_read_b64_tr_b16 v[50:51], v198 offset:63488
    s_waitcnt lgkmcnt(6)
    v_mfma_f32_16x16x32_bf16 v[4:7], v[36:39], v[80:83], v[4:7]
    v_mfma_f32_16x16x32_bf16 v[20:23], v[36:39], v[84:87], v[20:23]
    ds_read_b64_tr_b16 v[52:53], v199 offset:61440
    ds_read_b64_tr_b16 v[54:55], v199 offset:63488
    s_waitcnt lgkmcnt(6)
    v_mfma_f32_16x16x32_bf16 v[8:11], v[40:43], v[80:83], v[8:11]
    v_mfma_f32_16x16x32_bf16 v[24:27], v[40:43], v[84:87], v[24:27]
    ds_read_b64_tr_b16 v[56:57], v200 offset:61440
    ds_read_b64_tr_b16 v[58:59], v200 offset:63488
    s_waitcnt lgkmcnt(6)
    v_mfma_f32_16x16x32_bf16 v[12:15], v[44:47], v[80:83], v[12:15]
    v_mfma_f32_16x16x32_bf16 v[28:31], v[44:47], v[84:87], v[28:31]
    ds_read_b64_tr_b16 v[60:61], v201 offset:61440
    ds_read_b64_tr_b16 v[62:63], v201 offset:63488
    s_waitcnt lgkmcnt(6)
    s_waitcnt vmcnt(1)
    v_mfma_f32_16x16x32_bf16 v[0:3], v[48:51], v[88:91], v[0:3]
    s_waitcnt vmcnt(0)
    v_mfma_f32_16x16x32_bf16 v[16:19], v[48:51], v[92:95], v[16:19]
    s_waitcnt lgkmcnt(4)
    v_mfma_f32_16x16x32_bf16 v[4:7], v[52:55], v[88:91], v[4:7]
    v_mfma_f32_16x16x32_bf16 v[20:23], v[52:55], v[92:95], v[20:23]
    s_waitcnt lgkmcnt(2)
    v_mfma_f32_16x16x32_bf16 v[8:11], v[56:59], v[88:91], v[8:11]
    v_mfma_f32_16x16x32_bf16 v[24:27], v[56:59], v[92:95], v[24:27]
    s_waitcnt lgkmcnt(0)
    v_mfma_f32_16x16x32_bf16 v[12:15], v[60:63], v[88:91], v[12:15]
    v_mfma_f32_16x16x32_bf16 v[28:31], v[60:63], v[92:95], v[28:31]
    s_lshl_b32 s42, s70, 7
    s_lshl_b32 s43, s3, 5
    s_add_u32 s42, s42, s43
    s_lshl_b32 s42, s42, 12
    s_lshl_b32 s43, s71, 7
    s_add_u32 s42, s42, s43
    s_add_u32 s43, s42, 65536
    v_cvt_pk_bf16_f32 v32, v0, v1
    v_cvt_pk_bf16_f32 v33, v2, v3
    v_cvt_pk_bf16_f32 v34, v4, v5
    v_cvt_pk_bf16_f32 v35, v6, v7
    v_cvt_pk_bf16_f32 v36, v8, v9
    v_cvt_pk_bf16_f32 v37, v10, v11
    v_cvt_pk_bf16_f32 v38, v12, v13
    v_cvt_pk_bf16_f32 v39, v14, v15
    v_cvt_pk_bf16_f32 v40, v16, v17
    v_cvt_pk_bf16_f32 v41, v18, v19
    v_cvt_pk_bf16_f32 v42, v20, v21
    v_cvt_pk_bf16_f32 v43, v22, v23
    v_cvt_pk_bf16_f32 v44, v24, v25
    v_cvt_pk_bf16_f32 v45, v26, v27
    v_cvt_pk_bf16_f32 v46, v28, v29
    v_cvt_pk_bf16_f32 v47, v30, v31
    v_permlane16_swap_b32 v32, v34
    v_permlane16_swap_b32 v33, v35
    v_permlane16_swap_b32 v36, v38
    v_permlane16_swap_b32 v37, v39
    v_permlane16_swap_b32 v40, v42
    v_permlane16_swap_b32 v41, v43
    v_permlane16_swap_b32 v44, v46
    v_permlane16_swap_b32 v45, v47
    v_mov_b32 v48, v32
    v_mov_b32 v49, v33
    v_mov_b32 v50, v34
    v_mov_b32 v51, v35
    v_mov_b32 v52, v40
    v_mov_b32 v53, v41
    v_mov_b32 v54, v42
    v_mov_b32 v55, v43
    v_mov_b32_dpp v32, v36 row_ror:8 row_mask:0xf bank_mask:0xc
    v_mov_b32_dpp v33, v37 row_ror:8 row_mask:0xf bank_mask:0xc
    v_mov_b32_dpp v34, v38 row_ror:8 row_mask:0xf bank_mask:0xc
    v_mov_b32_dpp v35, v39 row_ror:8 row_mask:0xf bank_mask:0xc
    v_mov_b32_dpp v40, v44 row_ror:8 row_mask:0xf bank_mask:0xc
    v_mov_b32_dpp v41, v45 row_ror:8 row_mask:0xf bank_mask:0xc
    v_mov_b32_dpp v42, v46 row_ror:8 row_mask:0xf bank_mask:0xc
    v_mov_b32_dpp v43, v47 row_ror:8 row_mask:0xf bank_mask:0xc
    v_mov_b32_dpp v36, v48 row_ror:8 row_mask:0xf bank_mask:0x3
    v_mov_b32_dpp v37, v49 row_ror:8 row_mask:0xf bank_mask:0x3
    v_mov_b32_dpp v38, v50 row_ror:8 row_mask:0xf bank_mask:0x3
    v_mov_b32_dpp v39, v51 row_ror:8 row_mask:0xf bank_mask:0x3
    v_mov_b32_dpp v44, v52 row_ror:8 row_mask:0xf bank_mask:0x3
    v_mov_b32_dpp v45, v53 row_ror:8 row_mask:0xf bank_mask:0x3
    v_mov_b32_dpp v46, v54 row_ror:8 row_mask:0xf bank_mask:0x3
    v_mov_b32_dpp v47, v55 row_ror:8 row_mask:0xf bank_mask:0x3
    buffer_store_dwordx4 v[32:35], v204, s[64:67], s42 offen sc0 sc1
    s_add_u32 s42, s42, 32768
    buffer_store_dwordx4 v[36:39], v204, s[64:67], s42 offen sc0 sc1
    buffer_store_dwordx4 v[40:43], v204, s[64:67], s43 offen sc0 sc1
    s_add_u32 s43, s43, 32768
    buffer_store_dwordx4 v[44:47], v204, s[64:67], s43 offen sc0 sc1
    s_waitcnt vmcnt(0)
    s_waitcnt vmcnt(0)
    s_endpgm
L_loader:
    s_sub_u32 s53, s3, 4
    v_lshrrev_b32 v1, 3, v0
    v_and_b32 v2, 7, v0
    s_lshl_b32 s42, s40, 7
    s_lshl_b32 s43, s53, 5
    s_add_u32 s42, s42, s43
    v_add_u32 v3, s42, v1
    v_lshlrev_b32 v3, 11, v3
    v_lshrrev_b32 v4, 1, v1
    v_xor_b32 v5, v2, v4
    v_lshlrev_b32 v5, 4, v5
    v_add_u32 v5, v5, v3
    v_add_u32 v10, 0, v5
    v_xor_b32 v5, v2, v4
    v_xor_b32 v5, 4, v5
    v_lshlrev_b32 v5, 4, v5
    v_add_u32 v5, v5, v3
    v_add_u32 v11, 16384, v5
    v_xor_b32 v5, v2, v4
    v_lshlrev_b32 v5, 4, v5
    v_add_u32 v5, v5, v3
    v_add_u32 v12, 32768, v5
    v_xor_b32 v5, v2, v4
    v_xor_b32 v5, 4, v5
    v_lshlrev_b32 v5, 4, v5
    v_add_u32 v5, v5, v3
    v_add_u32 v13, 49152, v5
    s_lshl_b32 s42, s53, 4
    v_add_u32 v3, s42, v1
    s_mov_b32 s43, 6144
    v_mul_lo_u32 v3, v3, s43
    s_lshl_b32 s42, s41, 7
    v_add_u32 v3, s42, v3
    v_bfe_u32 v4, v1, 1, 1
    v_lshlrev_b32 v4, 1, v4
    v_xor_b32 v4, v2, v4
    v_xor_b32 v5, 0, v4
    v_lshlrev_b32 v5, 4, v5
    v_add_u32 v5, v3, v5
    v_add_u32 v14, 0, v5
    v_add_u32 v16, 2048, v5
    v_add_u32 v18, 4096, v5
    v_xor_b32 v5, 4, v4
    v_lshlrev_b32 v5, 4, v5
    v_add_u32 v5, v3, v5
    v_add_u32 v15, 49152, v5
    v_add_u32 v17, 51200, v5
    v_add_u32 v19, 53248, v5
    s_lshl_b32 s50, s53, 12
    s_lshl_b32 s51, s53, 11
    s_add_u32 s51, s51, 16384
    s_add_u32 s54, s40, s41
    s_and_b32 s54, s54, 15
    s_lshl_b32 s47, s54, 7
    s_mul_i32 s48, s54, 393216
    s_waitcnt lgkmcnt(0)
    s_mov_b32 s24, s4
    s_mov_b32 s25, s5
    s_mov_b32 s26, 4194304
    s_mov_b32 s27, 0x00020000
    s_mov_b32 s28, s6
    s_mov_b32 s29, s7
    s_mov_b32 s30, 6291456
    s_mov_b32 s31, 0x00020000
    s_mov_b32 s32, s20
    s_mov_b32 s33, s21
    s_mov_b32 s34, 268435456
    s_mov_b32 s35, 0x00020000
    s_add_u32 m0, s50, 0
    s_nop 0
    buffer_load_dwordx4 v10, s[24:27], s47 offen lds
    s_add_u32 m0, s50, 1024
    s_nop 0
    buffer_load_dwordx4 v11, s[24:27], s47 offen lds
    s_add_u32 m0, s50, 2048
    s_nop 0
    buffer_load_dwordx4 v12, s[24:27], s47 offen lds
    s_add_u32 m0, s50, 3072
    s_nop 0
    buffer_load_dwordx4 v13, s[24:27], s47 offen lds
    s_add_u32 m0, s51, 0
    s_nop 0
    buffer_load_dwordx4 v14, s[28:31], s48 offen lds
    s_add_u32 m0, s51, 1024
    s_nop 0
    buffer_load_dwordx4 v15, s[28:31], s48 offen lds
    s_add_u32 m0, s51, 8192
    s_nop 0
    buffer_load_dwordx4 v16, s[28:31], s48 offen lds
    s_add_u32 m0, s51, 9216
    s_nop 0
    buffer_load_dwordx4 v17, s[28:31], s48 offen lds
    s_add_u32 m0, s51, 16384
    s_nop 0
    buffer_load_dwordx4 v18, s[28:31], s48 offen lds
    s_add_u32 m0, s51, 17408
    s_nop 0
    buffer_load_dwordx4 v19, s[28:31], s48 offen lds
    s_add_u32 s54, s54, 1
    s_and_b32 s54, s54, 15
    s_lshl_b32 s47, s54, 7
    s_mul_i32 s48, s54, 393216
    v_mov_b32 v31, 0
    buffer_load_dword v30, v31, s[32:35], 0 offen sc1
    s_mov_b32 s80, s10
    s_mov_b32 s81, s11
    s_mov_b32 s82, 4194304
    s_mov_b32 s83, 0x00020000
    s_sub_u32 s76, s3, 4
    s_lshr_b32 s75, s2, 5
    s_lshl_b32 s75, s75, 2
    s_add_u32 s75, s75, s76
    s_lshl_b32 s75, s75, 5
    s_and_b32 s77, s2, 31
    s_add_u32 s75, s75, s77
    s_lshl_b32 s75, s75, 12
    v_lshrrev_b32 v1, 3, v0
    v_and_b32 v1, 2, v1
    v_xor_b32 v1, v1, v0
    v_lshlrev_b32 v1, 4, v1
    s_lshl_b32 s76, s76, 12
    s_add_u32 m0, s76, 122880
    s_nop 0
    buffer_load_dwordx4 v1, s[80:83], s75 offen lds
    s_add_u32 s75, s75, 1024
    s_add_u32 m0, s76, 123904
    s_nop 0
    buffer_load_dwordx4 v1, s[80:83], s75 offen lds
    s_add_u32 s75, s75, 1024
    s_add_u32 m0, s76, 124928
    s_nop 0
    buffer_load_dwordx4 v1, s[80:83], s75 offen lds
    s_add_u32 s75, s75, 1024
    s_add_u32 m0, s76, 125952
    s_nop 0
    buffer_load_dwordx4 v1, s[80:83], s75 offen lds
    v_lshlrev_b32 v2, 2, v0
    v_add_u32 v2, 160256, v2
    v_mov_b32 v3, 0
    ds_write_b32 v2, v3
    ds_write_b32 v2, v3 offset:256
    s_add_u32 m0, s50, 40960
    s_nop 0
    buffer_load_dwordx4 v10, s[24:27], s47 offen lds
    s_add_u32 m0, s50, 41984
    s_nop 0
    buffer_load_dwordx4 v11, s[24:27], s47 offen lds
    s_add_u32 m0, s50, 43008
    s_nop 0
    buffer_load_dwordx4 v12, s[24:27], s47 offen lds
    s_add_u32 m0, s50, 44032
    s_nop 0
    buffer_load_dwordx4 v13, s[24:27], s47 offen lds
    s_add_u32 m0, s51, 40960
    s_nop 0
    buffer_load_dwordx4 v14, s[28:31], s48 offen lds
    s_add_u32 m0, s51, 41984
    s_nop 0
    buffer_load_dwordx4 v15, s[28:31], s48 offen lds
    s_add_u32 m0, s51, 49152
    s_nop 0
    buffer_load_dwordx4 v16, s[28:31], s48 offen lds
    s_add_u32 m0, s51, 50176
    s_nop 0
    buffer_load_dwordx4 v17, s[28:31], s48 offen lds
    s_add_u32 m0, s51, 57344
    s_nop 0
    buffer_load_dwordx4 v18, s[28:31], s48 offen lds
    s_add_u32 m0, s51, 58368
    s_nop 0
    buffer_load_dwordx4 v19, s[28:31], s48 offen lds
    s_add_u32 s54, s54, 1
    s_and_b32 s54, s54, 15
    s_lshl_b32 s47, s54, 7
    s_mul_i32 s48, s54, 393216
    s_sub_u32 s75, s3, 4
    s_and_b32 s72, s75, 1
    s_lshr_b32 s73, s75, 1
    v_lshrrev_b32 v84, 4, v0
    v_lshlrev_b32 v84, 2, v84
    v_cvt_f32_u32 v240, v84
    v_and_b32 v84, 15, v0
    v_cvt_f32_u32 v248, v84
    v_add_f32 v241, 1.0, v240
    v_add_f32 v242, 2.0, v240
    v_add_f32 v243, 0x40400000, v240
    v_add_f32 v244, 0x41800000, v240
    v_add_f32 v245, 0x41800000, v241
    v_add_f32 v246, 0x41800000, v242
    v_add_f32 v247, 0x41800000, v243
    v_mul_f32 v96, 0x3d000000, v248
    v_mul_f32 v84, v240, v96
    v_mul_f32 v85, v241, v96
    v_mul_f32 v86, v242, v96
    v_mul_f32 v87, v243, v96
    v_fract_f32 v84, v84
    v_fract_f32 v85, v85
    v_fract_f32 v86, v86
    v_fract_f32 v87, v87
    v_cos_f32 v88, v84
    v_cos_f32 v89, v85
    v_cos_f32 v90, v86
    v_cos_f32 v91, v87
    v_sin_f32 v92, v84
    v_sin_f32 v93, v85
    v_sin_f32 v94, v86
    v_sin_f32 v95, v87
    v_cvt_pk_bf16_f32 v34, v88, v89
    v_cvt_pk_bf16_f32 v35, v90, v91
    v_cvt_pk_bf16_f32 v36, v92, v93
    v_cvt_pk_bf16_f32 v37, v94, v95
    v_xor_b32 v32, 2147516416, v36
    v_xor_b32 v33, 2147516416, v37
    v_mul_f32 v84, v244, v96
    v_mul_f32 v85, v245, v96
    v_mul_f32 v86, v246, v96
    v_mul_f32 v87, v247, v96
    v_fract_f32 v84, v84
    v_fract_f32 v85, v85
    v_fract_f32 v86, v86
    v_fract_f32 v87, v87
    v_cos_f32 v88, v84
    v_cos_f32 v89, v85
    v_cos_f32 v90, v86
    v_cos_f32 v91, v87
    v_sin_f32 v92, v84
    v_sin_f32 v93, v85
    v_sin_f32 v94, v86
    v_sin_f32 v95, v87
    v_cvt_pk_bf16_f32 v40, v88, v89
    v_cvt_pk_bf16_f32 v41, v90, v91
    v_cvt_pk_bf16_f32 v42, v92, v93
    v_cvt_pk_bf16_f32 v43, v94, v95
    v_xor_b32 v38, 2147516416, v42
    v_xor_b32 v39, 2147516416, v43
    v_add_f32 v96, 0.5, v96
    v_mul_f32 v84, v240, v96
    v_mul_f32 v85, v241, v96
    v_mul_f32 v86, v242, v96
    v_mul_f32 v87, v243, v96
    v_fract_f32 v84, v84
    v_fract_f32 v85, v85
    v_fract_f32 v86, v86
    v_fract_f32 v87, v87
    v_cos_f32 v88, v84
    v_cos_f32 v89, v85
    v_cos_f32 v90, v86
    v_cos_f32 v91, v87
    v_sin_f32 v92, v84
    v_sin_f32 v93, v85
    v_sin_f32 v94, v86
    v_sin_f32 v95, v87
    v_cvt_pk_bf16_f32 v46, v88, v89
    v_cvt_pk_bf16_f32 v47, v90, v91
    v_cvt_pk_bf16_f32 v48, v92, v93
    v_cvt_pk_bf16_f32 v49, v94, v95
    v_xor_b32 v44, 2147516416, v48
    v_xor_b32 v45, 2147516416, v49
    v_mul_f32 v84, v244, v96
    v_mul_f32 v85, v245, v96
    v_mul_f32 v86, v246, v96
    v_mul_f32 v87, v247, v96
    v_fract_f32 v84, v84
    v_fract_f32 v85, v85
    v_fract_f32 v86, v86
    v_fract_f32 v87, v87
    v_cos_f32 v88, v84
    v_cos_f32 v89, v85
    v_cos_f32 v90, v86
    v_cos_f32 v91, v87
    v_sin_f32 v92, v84
    v_sin_f32 v93, v85
    v_sin_f32 v94, v86
    v_sin_f32 v95, v87
    v_cvt_pk_bf16_f32 v52, v88, v89
    v_cvt_pk_bf16_f32 v53, v90, v91
    v_cvt_pk_bf16_f32 v54, v92, v93
    v_cvt_pk_bf16_f32 v55, v94, v95
    v_xor_b32 v50, 2147516416, v54
    v_xor_b32 v51, 2147516416, v55
    s_cmp_eq_u32 s72, 0
    s_cselect_b64 vcc, -1, 0
    v_cndmask_b32 v56, v44, v32, vcc
    v_cndmask_b32 v57, v45, v33, vcc
    v_cndmask_b32 v58, v46, v34, vcc
    v_cndmask_b32 v59, v47, v35, vcc
    v_cndmask_b32 v60, v48, v36, vcc
    v_cndmask_b32 v61, v49, v37, vcc
    v_cndmask_b32 v62, v50, v38, vcc
    v_cndmask_b32 v63, v51, v39, vcc
    v_cndmask_b32 v64, v52, v40, vcc
    v_cndmask_b32 v65, v53, v41, vcc
    v_cndmask_b32 v66, v54, v42, vcc
    v_cndmask_b32 v67, v55, v43, vcc
    s_cmp_eq_u32 s73, 0
    s_cselect_b64 vcc, -1, 0
    v_cndmask_b32 v228, v44, v32, vcc
    v_cndmask_b32 v229, v45, v33, vcc
    v_cndmask_b32 v230, v46, v34, vcc
    v_cndmask_b32 v231, v47, v35, vcc
    v_cndmask_b32 v232, v48, v36, vcc
    v_cndmask_b32 v233, v49, v37, vcc
    v_cndmask_b32 v234, v50, v38, vcc
    v_cndmask_b32 v235, v51, v39, vcc
    v_cndmask_b32 v236, v52, v40, vcc
    v_cndmask_b32 v237, v53, v41, vcc
    v_cndmask_b32 v238, v54, v42, vcc
    v_cndmask_b32 v239, v55, v43, vcc
    s_lshl_b32 s75, s72, 4
    v_cvt_f32_u32 v96, s75
    v_add_f32 v96, v96, v248
    v_mul_f32 v96, 0x3a800000, v96
    v_mul_f32 v84, v240, v96
    v_mul_f32 v85, v241, v96
    v_mul_f32 v86, v242, v96
    v_mul_f32 v87, v243, v96
    v_cos_f32 v68, v84
    v_cos_f32 v69, v85
    v_cos_f32 v70, v86
    v_cos_f32 v71, v87
    v_sin_f32 v72, v84
    v_sin_f32 v73, v85
    v_sin_f32 v74, v86
    v_sin_f32 v75, v87
    v_mul_f32 v84, v244, v96
    v_mul_f32 v85, v245, v96
    v_mul_f32 v86, v246, v96
    v_mul_f32 v87, v247, v96
    v_cos_f32 v76, v84
    v_cos_f32 v77, v85
    v_cos_f32 v78, v86
    v_cos_f32 v79, v87
    v_sin_f32 v80, v84
    v_sin_f32 v81, v85
    v_sin_f32 v82, v86
    v_sin_f32 v83, v87
    s_waitcnt lgkmcnt(0)
    s_setprio 3
    s_waitcnt vmcnt(15)
    s_barrier
    s_add_u32 m0, s50, 81920
    s_nop 0
    buffer_load_dwordx4 v10, s[24:27], s47 offen lds
    s_add_u32 m0, s50, 82944
    s_nop 0
    buffer_load_dwordx4 v11, s[24:27], s47 offen lds
    s_add_u32 m0, s50, 83968
    s_nop 0
    buffer_load_dwordx4 v12, s[24:27], s47 offen lds
    s_add_u32 m0, s50, 84992
    s_nop 0
    buffer_load_dwordx4 v13, s[24:27], s47 offen lds
    s_add_u32 m0, s51, 81920
    s_nop 0
    buffer_load_dwordx4 v14, s[28:31], s48 offen lds
    s_add_u32 m0, s51, 82944
    s_nop 0
    buffer_load_dwordx4 v15, s[28:31], s48 offen lds
    s_add_u32 m0, s51, 90112
    s_nop 0
    buffer_load_dwordx4 v16, s[28:31], s48 offen lds
    s_add_u32 m0, s51, 91136
    s_nop 0
    buffer_load_dwordx4 v17, s[28:31], s48 offen lds
    s_add_u32 m0, s51, 98304
    s_nop 0
    buffer_load_dwordx4 v18, s[28:31], s48 offen lds
    s_add_u32 m0, s51, 99328
    s_nop 0
    buffer_load_dwordx4 v19, s[28:31], s48 offen lds
    s_add_u32 s54, s54, 1
    s_and_b32 s54, s54, 15
    s_lshl_b32 s47, s54, 7
    s_mul_i32 s48, s54, 393216
    s_waitcnt vmcnt(24)
    v_readfirstlane_b32 s42, v30
    s_mul_i32 s56, s42, 1664525
    s_add_u32 s56, s56, 1013904223
    s_or_b32 s56, s56, 1
    s_cmp_eq_u32 s56, s42
    s_cselect_b32 s43, 2, 0
    s_add_u32 s56, s56, s43
    v_mov_b32 v20, s56
    v_mov_b32 v21, 0
    v_and_b32 v22, 3, v0
    v_lshlrev_b32 v22, 2, v22
    v_add_u32 v22, 160304, v22
    s_lshl_b32 s75, s53, 2
    s_add_u32 s75, s75, 160304
    v_mov_b32 v23, s75
    s_and_b32 s42, s2, 7
    s_lshr_b32 s43, s2, 3
    s_and_b32 s70, s42, 3
    s_lshl_b32 s70, s70, 2
    s_and_b32 s44, s43, 3
    s_add_u32 s70, s70, s44
    s_lshr_b32 s71, s42, 2
    s_lshl_b32 s71, s71, 3
    s_lshr_b32 s44, s43, 2
    s_add_u32 s71, s71, s44
    v_lshrrev_b32 v24, 2, v0
    v_lshlrev_b32 v24, 6, v24
    v_bfe_u32 v25, v0, 4, 1
    v_lshl_add_u32 v24, v25, 5, v24
    v_and_b32 v25, 3, v0
    v_lshl_add_u32 v24, v25, 3, v24
    v_add_u32 v24, 122880, v24
    v_xor_b32 v25, 32, v24
    v_lshrrev_b32 v84, 4, v0
    v_lshlrev_b32 v84, 7, v84
    v_and_b32 v85, 15, v0
    s_lshl_b32 s75, s72, 4
    v_add3_u32 v84, v84, v85, s75
    v_sub_u32 v85, 512, v84
    s_cmp_eq_u32 s73, 0
    s_cselect_b64 vcc, -1, 0
    s_movk_i32 s76, 1024
    s_cselect_b32 s76, s76, 4294966272
    s_cselect_b32 s74, 0, 2147516416
    v_cndmask_b32 v84, v85, v84, vcc
    v_lshrrev_b32 v85, 1, v84
    v_lshlrev_b32 v85, 6, v85
    v_and_b32 v84, 1, v84
    v_lshl_add_u32 v84, v84, 4, v85
    s_lshl_b32 s75, s73, 5
    v_add_u32 v26, s75, v84
    v_add_u32 v27, s76, v26
    v_add_u32 v28, s76, v27
    v_add_u32 v29, s76, v28
    v_and_b32 v26, 16383, v26
    v_and_b32 v27, 16383, v27
    v_and_b32 v28, 16383, v28
    v_and_b32 v29, 16383, v29
    v_add_u32 v26, 139264, v26
    v_add_u32 v27, 139264, v27
    v_add_u32 v28, 139264, v28
    v_add_u32 v29, 139264, v29
    s_waitcnt vmcnt(10)
    s_barrier
    s_add_u32 m0, s50, 0
    s_nop 0
    buffer_load_dwordx4 v10, s[24:27], s47 offen lds
    s_add_u32 m0, s50, 1024
    s_nop 0
    buffer_load_dwordx4 v11, s[24:27], s47 offen lds
    s_add_u32 m0, s50, 2048
    s_nop 0
    buffer_load_dwordx4 v12, s[24:27], s47 offen lds
    s_add_u32 m0, s50, 3072
    s_nop 0
    buffer_load_dwordx4 v13, s[24:27], s47 offen lds
    s_add_u32 m0, s51, 0
    s_nop 0
    buffer_load_dwordx4 v14, s[28:31], s48 offen lds
    s_add_u32 m0, s51, 1024
    s_nop 0
    buffer_load_dwordx4 v15, s[28:31], s48 offen lds
    s_add_u32 m0, s51, 8192
    s_nop 0
    buffer_load_dwordx4 v16, s[28:31], s48 offen lds
    s_add_u32 m0, s51, 9216
    s_nop 0
    buffer_load_dwordx4 v17, s[28:31], s48 offen lds
    s_add_u32 m0, s51, 16384
    s_nop 0
    buffer_load_dwordx4 v18, s[28:31], s48 offen lds
    s_add_u32 m0, s51, 17408
    s_nop 0
    buffer_load_dwordx4 v19, s[28:31], s48 offen lds
    s_add_u32 s54, s54, 1
    s_and_b32 s54, s54, 15
    s_lshl_b32 s47, s54, 7
    s_mul_i32 s48, s54, 393216
    ds_read_b64_tr_b16 v[100:101], v24 offset:0
    ds_read_b64_tr_b16 v[102:103], v24 offset:2048
    ds_read_b64_tr_b16 v[104:105], v24 offset:1024
    ds_read_b64_tr_b16 v[106:107], v24 offset:3072
    ds_read_b64_tr_b16 v[108:109], v25 offset:0
    ds_read_b64_tr_b16 v[110:111], v25 offset:2048
    ds_read_b64_tr_b16 v[112:113], v25 offset:1024
    ds_read_b64_tr_b16 v[114:115], v25 offset:3072
    ds_read_b64_tr_b16 v[116:117], v24 offset:4096
    ds_read_b64_tr_b16 v[118:119], v24 offset:6144
    ds_read_b64_tr_b16 v[120:121], v24 offset:5120
    ds_read_b64_tr_b16 v[122:123], v24 offset:7168
    ds_read_b64_tr_b16 v[124:125], v25 offset:4096
    ds_read_b64_tr_b16 v[126:127], v25 offset:6144
    ds_read_b64_tr_b16 v[128:129], v25 offset:5120
    ds_read_b64_tr_b16 v[130:131], v25 offset:7168
    s_waitcnt lgkmcnt(14)
    v_mfma_f32_16x16x32_bf16 v[164:167], v[100:103], v[58:61], 0
    v_mfma_f32_16x16x32_bf16 v[168:171], v[100:103], v[56:59], 0
    s_waitcnt lgkmcnt(12)
    v_mfma_f32_16x16x32_bf16 v[164:167], v[104:107], v[64:67], v[164:167]
    v_mfma_f32_16x16x32_bf16 v[168:171], v[104:107], v[62:65], v[168:171]
    s_waitcnt lgkmcnt(10)
    v_mfma_f32_16x16x32_bf16 v[172:175], v[108:111], v[58:61], 0
    v_mfma_f32_16x16x32_bf16 v[176:179], v[108:111], v[56:59], 0
    s_waitcnt lgkmcnt(8)
    v_mfma_f32_16x16x32_bf16 v[172:175], v[112:115], v[64:67], v[172:175]
    v_mfma_f32_16x16x32_bf16 v[176:179], v[112:115], v[62:65], v[176:179]
    ds_read_b64_tr_b16 v[132:133], v24 offset:8192
    ds_read_b64_tr_b16 v[134:135], v24 offset:10240
    ds_read_b64_tr_b16 v[136:137], v24 offset:9216
    ds_read_b64_tr_b16 v[138:139], v24 offset:11264
    ds_read_b64_tr_b16 v[140:141], v25 offset:8192
    ds_read_b64_tr_b16 v[142:143], v25 offset:10240
    ds_read_b64_tr_b16 v[144:145], v25 offset:9216
    ds_read_b64_tr_b16 v[146:147], v25 offset:11264
    s_waitcnt lgkmcnt(14)
    v_mfma_f32_16x16x32_bf16 v[180:183], v[116:119], v[58:61], 0
    v_mfma_f32_16x16x32_bf16 v[184:187], v[116:119], v[56:59], 0
    s_waitcnt lgkmcnt(12)
    v_mfma_f32_16x16x32_bf16 v[180:183], v[120:123], v[64:67], v[180:183]
    v_mfma_f32_16x16x32_bf16 v[184:187], v[120:123], v[62:65], v[184:187]
    s_waitcnt lgkmcnt(10)
    v_mfma_f32_16x16x32_bf16 v[188:191], v[124:127], v[58:61], 0
    v_mfma_f32_16x16x32_bf16 v[192:195], v[124:127], v[56:59], 0
    s_waitcnt lgkmcnt(8)
    v_mfma_f32_16x16x32_bf16 v[188:191], v[128:131], v[64:67], v[188:191]
    v_mfma_f32_16x16x32_bf16 v[192:195], v[128:131], v[62:65], v[192:195]
    ds_read_b64_tr_b16 v[148:149], v24 offset:12288
    ds_read_b64_tr_b16 v[150:151], v24 offset:14336
    ds_read_b64_tr_b16 v[152:153], v24 offset:13312
    ds_read_b64_tr_b16 v[154:155], v24 offset:15360
    ds_read_b64_tr_b16 v[156:157], v25 offset:12288
    ds_read_b64_tr_b16 v[158:159], v25 offset:14336
    ds_read_b64_tr_b16 v[160:161], v25 offset:13312
    ds_read_b64_tr_b16 v[162:163], v25 offset:15360
    s_waitcnt vmcnt(10)
    s_barrier
    s_add_u32 m0, s50, 40960
    s_nop 0
    buffer_load_dwordx4 v10, s[24:27], s47 offen lds
    s_add_u32 m0, s50, 41984
    s_nop 0
    buffer_load_dwordx4 v11, s[24:27], s47 offen lds
    s_add_u32 m0, s50, 43008
    s_nop 0
    buffer_load_dwordx4 v12, s[24:27], s47 offen lds
    s_add_u32 m0, s50, 44032
    s_nop 0
    buffer_load_dwordx4 v13, s[24:27], s47 offen lds
    s_add_u32 m0, s51, 40960
    s_nop 0
    buffer_load_dwordx4 v14, s[28:31], s48 offen lds
    s_add_u32 m0, s51, 41984
    s_nop 0
    buffer_load_dwordx4 v15, s[28:31], s48 offen lds
    s_add_u32 m0, s51, 49152
    s_nop 0
    buffer_load_dwordx4 v16, s[28:31], s48 offen lds
    s_add_u32 m0, s51, 50176
    s_nop 0
    buffer_load_dwordx4 v17, s[28:31], s48 offen lds
    s_add_u32 m0, s51, 57344
    s_nop 0
    buffer_load_dwordx4 v18, s[28:31], s48 offen lds
    s_add_u32 m0, s51, 58368
    s_nop 0
    buffer_load_dwordx4 v19, s[28:31], s48 offen lds
    s_add_u32 s54, s54, 1
    s_and_b32 s54, s54, 15
    s_lshl_b32 s47, s54, 7
    s_mul_i32 s48, s54, 393216
    v_pk_mul_f32 v[84:85], v[164:165], v[68:69]
    v_pk_mul_f32 v[86:87], v[166:167], v[70:71]
    v_pk_mul_f32 v[88:89], v[168:169], v[68:69]
    v_pk_mul_f32 v[90:91], v[170:171], v[70:71]
    v_pk_fma_f32 v[84:85], v[168:169], v[72:73], v[84:85]
    v_pk_fma_f32 v[86:87], v[170:171], v[74:75], v[86:87]
    v_pk_fma_f32 v[88:89], v[164:165], v[72:73], v[88:89] neg_lo:[1,0,0] neg_hi:[1,0,0]
    v_pk_fma_f32 v[90:91], v[166:167], v[74:75], v[90:91] neg_lo:[1,0,0] neg_hi:[1,0,0]
    v_cvt_pk_bf16_f32 v100, v84, v85
    v_cvt_pk_bf16_f32 v101, v86, v87
    v_cvt_pk_bf16_f32 v102, v88, v89
    v_cvt_pk_bf16_f32 v103, v90, v91
    v_pk_mul_f32 v[92:93], v[172:173], v[76:77]
    v_pk_mul_f32 v[94:95], v[174:175], v[78:79]
    v_pk_mul_f32 v[96:97], v[176:177], v[76:77]
    v_pk_mul_f32 v[98:99], v[178:179], v[78:79]
    v_pk_fma_f32 v[92:93], v[176:177], v[80:81], v[92:93]
    v_pk_fma_f32 v[94:95], v[178:179], v[82:83], v[94:95]
    v_pk_fma_f32 v[96:97], v[172:173], v[80:81], v[96:97] neg_lo:[1,0,0] neg_hi:[1,0,0]
    v_pk_fma_f32 v[98:99], v[174:175], v[82:83], v[98:99] neg_lo:[1,0,0] neg_hi:[1,0,0]
    v_cvt_pk_bf16_f32 v104, v92, v93
    v_cvt_pk_bf16_f32 v105, v94, v95
    v_cvt_pk_bf16_f32 v106, v96, v97
    v_cvt_pk_bf16_f32 v107, v98, v99
    s_waitcnt lgkmcnt(14)
    v_mfma_f32_16x16x32_bf16 v[196:199], v[132:135], v[58:61], 0
    v_mfma_f32_16x16x32_bf16 v[200:203], v[132:135], v[56:59], 0
    s_waitcnt lgkmcnt(12)
    v_mfma_f32_16x16x32_bf16 v[196:199], v[136:139], v[64:67], v[196:199]
    v_mfma_f32_16x16x32_bf16 v[200:203], v[136:139], v[62:65], v[200:203]
    s_waitcnt lgkmcnt(10)
    v_mfma_f32_16x16x32_bf16 v[204:207], v[140:143], v[58:61], 0
    v_mfma_f32_16x16x32_bf16 v[208:211], v[140:143], v[56:59], 0
    s_waitcnt lgkmcnt(8)
    v_mfma_f32_16x16x32_bf16 v[204:207], v[144:147], v[64:67], v[204:207]
    v_mfma_f32_16x16x32_bf16 v[208:211], v[144:147], v[62:65], v[208:211]
    s_waitcnt vmcnt(10)
    s_barrier
    s_add_u32 m0, s50, 81920
    s_nop 0
    buffer_load_dwordx4 v10, s[24:27], s47 offen lds
    s_add_u32 m0, s50, 82944
    s_nop 0
    buffer_load_dwordx4 v11, s[24:27], s47 offen lds
    s_add_u32 m0, s50, 83968
    s_nop 0
    buffer_load_dwordx4 v12, s[24:27], s47 offen lds
    s_add_u32 m0, s50, 84992
    s_nop 0
    buffer_load_dwordx4 v13, s[24:27], s47 offen lds
    s_add_u32 m0, s51, 81920
    s_nop 0
    buffer_load_dwordx4 v14, s[28:31], s48 offen lds
    s_add_u32 m0, s51, 82944
    s_nop 0
    buffer_load_dwordx4 v15, s[28:31], s48 offen lds
    s_add_u32 m0, s51, 90112
    s_nop 0
    buffer_load_dwordx4 v16, s[28:31], s48 offen lds
    s_add_u32 m0, s51, 91136
    s_nop 0
    buffer_load_dwordx4 v17, s[28:31], s48 offen lds
    s_add_u32 m0, s51, 98304
    s_nop 0
    buffer_load_dwordx4 v18, s[28:31], s48 offen lds
    s_add_u32 m0, s51, 99328
    s_nop 0
    buffer_load_dwordx4 v19, s[28:31], s48 offen lds
    s_add_u32 s54, s54, 1
    s_and_b32 s54, s54, 15
    s_lshl_b32 s47, s54, 7
    s_mul_i32 s48, s54, 393216
    v_mfma_f32_16x16x32_bf16 v[164:167], v[230:233], v[100:103], 0
    v_mfma_f32_16x16x32_bf16 v[168:171], v[228:231], v[100:103], 0
    v_mfma_f32_16x16x32_bf16 v[164:167], v[236:239], v[104:107], v[164:167]
    v_mfma_f32_16x16x32_bf16 v[168:171], v[234:237], v[104:107], v[168:171]
    v_pk_mul_f32 v[84:85], v[180:181], v[68:69]
    v_pk_mul_f32 v[86:87], v[182:183], v[70:71]
    v_pk_mul_f32 v[88:89], v[184:185], v[68:69]
    v_pk_mul_f32 v[90:91], v[186:187], v[70:71]
    v_pk_fma_f32 v[84:85], v[184:185], v[72:73], v[84:85]
    v_pk_fma_f32 v[86:87], v[186:187], v[74:75], v[86:87]
    v_pk_fma_f32 v[88:89], v[180:181], v[72:73], v[88:89] neg_lo:[1,0,0] neg_hi:[1,0,0]
    v_pk_fma_f32 v[90:91], v[182:183], v[74:75], v[90:91] neg_lo:[1,0,0] neg_hi:[1,0,0]
    v_cvt_pk_bf16_f32 v116, v84, v85
    v_cvt_pk_bf16_f32 v117, v86, v87
    v_cvt_pk_bf16_f32 v118, v88, v89
    v_cvt_pk_bf16_f32 v119, v90, v91
    v_pk_mul_f32 v[92:93], v[188:189], v[76:77]
    v_pk_mul_f32 v[94:95], v[190:191], v[78:79]
    v_pk_mul_f32 v[96:97], v[192:193], v[76:77]
    v_pk_mul_f32 v[98:99], v[194:195], v[78:79]
    v_pk_fma_f32 v[92:93], v[192:193], v[80:81], v[92:93]
    v_pk_fma_f32 v[94:95], v[194:195], v[82:83], v[94:95]
    v_pk_fma_f32 v[96:97], v[188:189], v[80:81], v[96:97] neg_lo:[1,0,0] neg_hi:[1,0,0]
    v_pk_fma_f32 v[98:99], v[190:191], v[82:83], v[98:99] neg_lo:[1,0,0] neg_hi:[1,0,0]
    v_cvt_pk_bf16_f32 v120, v92, v93
    v_cvt_pk_bf16_f32 v121, v94, v95
    v_cvt_pk_bf16_f32 v122, v96, v97
    v_cvt_pk_bf16_f32 v123, v98, v99
    s_waitcnt lgkmcnt(6)
    v_mfma_f32_16x16x32_bf16 v[212:215], v[148:151], v[58:61], 0
    v_mfma_f32_16x16x32_bf16 v[216:219], v[148:151], v[56:59], 0
    s_waitcnt lgkmcnt(4)
    v_mfma_f32_16x16x32_bf16 v[212:215], v[152:155], v[64:67], v[212:215]
    v_mfma_f32_16x16x32_bf16 v[216:219], v[152:155], v[62:65], v[216:219]
    s_waitcnt lgkmcnt(2)
    v_mfma_f32_16x16x32_bf16 v[220:223], v[156:159], v[58:61], 0
    v_mfma_f32_16x16x32_bf16 v[224:227], v[156:159], v[56:59], 0
    s_waitcnt lgkmcnt(0)
    v_mfma_f32_16x16x32_bf16 v[220:223], v[160:163], v[64:67], v[220:223]
    v_mfma_f32_16x16x32_bf16 v[224:227], v[160:163], v[62:65], v[224:227]
    s_waitcnt vmcnt(10)
    s_barrier
    s_add_u32 m0, s50, 0
    s_nop 0
    buffer_load_dwordx4 v10, s[24:27], s47 offen lds
    s_add_u32 m0, s50, 1024
    s_nop 0
    buffer_load_dwordx4 v11, s[24:27], s47 offen lds
    s_add_u32 m0, s50, 2048
    s_nop 0
    buffer_load_dwordx4 v12, s[24:27], s47 offen lds
    s_add_u32 m0, s50, 3072
    s_nop 0
    buffer_load_dwordx4 v13, s[24:27], s47 offen lds
    s_add_u32 m0, s51, 0
    s_nop 0
    buffer_load_dwordx4 v14, s[28:31], s48 offen lds
    s_add_u32 m0, s51, 1024
    s_nop 0
    buffer_load_dwordx4 v15, s[28:31], s48 offen lds
    s_add_u32 m0, s51, 8192
    s_nop 0
    buffer_load_dwordx4 v16, s[28:31], s48 offen lds
    s_add_u32 m0, s51, 9216
    s_nop 0
    buffer_load_dwordx4 v17, s[28:31], s48 offen lds
    s_add_u32 m0, s51, 16384
    s_nop 0
    buffer_load_dwordx4 v18, s[28:31], s48 offen lds
    s_add_u32 m0, s51, 17408
    s_nop 0
    buffer_load_dwordx4 v19, s[28:31], s48 offen lds
    s_add_u32 s54, s54, 1
    s_and_b32 s54, s54, 15
    s_lshl_b32 s47, s54, 7
    s_mul_i32 s48, s54, 393216
    v_mfma_f32_16x16x32_bf16 v[180:183], v[230:233], v[116:119], 0
    v_mfma_f32_16x16x32_bf16 v[184:187], v[228:231], v[116:119], 0
    v_mfma_f32_16x16x32_bf16 v[180:183], v[236:239], v[120:123], v[180:183]
    v_mfma_f32_16x16x32_bf16 v[184:187], v[234:237], v[120:123], v[184:187]
    v_pk_mul_f32 v[84:85], v[196:197], v[68:69]
    v_pk_mul_f32 v[86:87], v[198:199], v[70:71]
    v_pk_mul_f32 v[88:89], v[200:201], v[68:69]
    v_pk_mul_f32 v[90:91], v[202:203], v[70:71]
    v_pk_fma_f32 v[84:85], v[200:201], v[72:73], v[84:85]
    v_pk_fma_f32 v[86:87], v[202:203], v[74:75], v[86:87]
    v_pk_fma_f32 v[88:89], v[196:197], v[72:73], v[88:89] neg_lo:[1,0,0] neg_hi:[1,0,0]
    v_pk_fma_f32 v[90:91], v[198:199], v[74:75], v[90:91] neg_lo:[1,0,0] neg_hi:[1,0,0]
    v_cvt_pk_bf16_f32 v132, v84, v85
    v_cvt_pk_bf16_f32 v133, v86, v87
    v_cvt_pk_bf16_f32 v134, v88, v89
    v_cvt_pk_bf16_f32 v135, v90, v91
    v_pk_mul_f32 v[92:93], v[204:205], v[76:77]
    v_pk_mul_f32 v[94:95], v[206:207], v[78:79]
    v_pk_mul_f32 v[96:97], v[208:209], v[76:77]
    v_pk_mul_f32 v[98:99], v[210:211], v[78:79]
    v_pk_fma_f32 v[92:93], v[208:209], v[80:81], v[92:93]
    v_pk_fma_f32 v[94:95], v[210:211], v[82:83], v[94:95]
    v_pk_fma_f32 v[96:97], v[204:205], v[80:81], v[96:97] neg_lo:[1,0,0] neg_hi:[1,0,0]
    v_pk_fma_f32 v[98:99], v[206:207], v[82:83], v[98:99] neg_lo:[1,0,0] neg_hi:[1,0,0]
    v_cvt_pk_bf16_f32 v136, v92, v93
    v_cvt_pk_bf16_f32 v137, v94, v95
    v_cvt_pk_bf16_f32 v138, v96, v97
    v_cvt_pk_bf16_f32 v139, v98, v99
    s_waitcnt vmcnt(10)
    s_barrier
    s_add_u32 m0, s50, 40960
    s_nop 0
    buffer_load_dwordx4 v10, s[24:27], s47 offen lds
    s_add_u32 m0, s50, 41984
    s_nop 0
    buffer_load_dwordx4 v11, s[24:27], s47 offen lds
    s_add_u32 m0, s50, 43008
    s_nop 0
    buffer_load_dwordx4 v12, s[24:27], s47 offen lds
    s_add_u32 m0, s50, 44032
    s_nop 0
    buffer_load_dwordx4 v13, s[24:27], s47 offen lds
    s_add_u32 m0, s51, 40960
    s_nop 0
    buffer_load_dwordx4 v14, s[28:31], s48 offen lds
    s_add_u32 m0, s51, 41984
    s_nop 0
    buffer_load_dwordx4 v15, s[28:31], s48 offen lds
    s_add_u32 m0, s51, 49152
    s_nop 0
    buffer_load_dwordx4 v16, s[28:31], s48 offen lds
    s_add_u32 m0, s51, 50176
    s_nop 0
    buffer_load_dwordx4 v17, s[28:31], s48 offen lds
    s_add_u32 m0, s51, 57344
    s_nop 0
    buffer_load_dwordx4 v18, s[28:31], s48 offen lds
    s_add_u32 m0, s51, 58368
    s_nop 0
    buffer_load_dwordx4 v19, s[28:31], s48 offen lds
    s_add_u32 s54, s54, 1
    s_and_b32 s54, s54, 15
    s_lshl_b32 s47, s54, 7
    s_mul_i32 s48, s54, 393216
    v_mfma_f32_16x16x32_bf16 v[196:199], v[230:233], v[132:135], 0
    v_mfma_f32_16x16x32_bf16 v[200:203], v[228:231], v[132:135], 0
    v_mfma_f32_16x16x32_bf16 v[196:199], v[236:239], v[136:139], v[196:199]
    v_mfma_f32_16x16x32_bf16 v[200:203], v[234:237], v[136:139], v[200:203]
    v_pk_mul_f32 v[84:85], v[212:213], v[68:69]
    v_pk_mul_f32 v[86:87], v[214:215], v[70:71]
    v_pk_mul_f32 v[88:89], v[216:217], v[68:69]
    v_pk_mul_f32 v[90:91], v[218:219], v[70:71]
    v_pk_fma_f32 v[84:85], v[216:217], v[72:73], v[84:85]
    v_pk_fma_f32 v[86:87], v[218:219], v[74:75], v[86:87]
    v_pk_fma_f32 v[88:89], v[212:213], v[72:73], v[88:89] neg_lo:[1,0,0] neg_hi:[1,0,0]
    v_pk_fma_f32 v[90:91], v[214:215], v[74:75], v[90:91] neg_lo:[1,0,0] neg_hi:[1,0,0]
    v_cvt_pk_bf16_f32 v148, v84, v85
    v_cvt_pk_bf16_f32 v149, v86, v87
    v_cvt_pk_bf16_f32 v150, v88, v89
    v_cvt_pk_bf16_f32 v151, v90, v91
    v_pk_mul_f32 v[92:93], v[220:221], v[76:77]
    v_pk_mul_f32 v[94:95], v[222:223], v[78:79]
    v_pk_mul_f32 v[96:97], v[224:225], v[76:77]
    v_pk_mul_f32 v[98:99], v[226:227], v[78:79]
    v_pk_fma_f32 v[92:93], v[224:225], v[80:81], v[92:93]
    v_pk_fma_f32 v[94:95], v[226:227], v[82:83], v[94:95]
    v_pk_fma_f32 v[96:97], v[220:221], v[80:81], v[96:97] neg_lo:[1,0,0] neg_hi:[1,0,0]
    v_pk_fma_f32 v[98:99], v[222:223], v[82:83], v[98:99] neg_lo:[1,0,0] neg_hi:[1,0,0]
    v_cvt_pk_bf16_f32 v152, v92, v93
    v_cvt_pk_bf16_f32 v153, v94, v95
    v_cvt_pk_bf16_f32 v154, v96, v97
    v_cvt_pk_bf16_f32 v155, v98, v99
    v_mfma_f32_16x16x32_bf16 v[212:215], v[230:233], v[148:151], 0
    v_mfma_f32_16x16x32_bf16 v[216:219], v[228:231], v[148:151], 0
    v_mfma_f32_16x16x32_bf16 v[212:215], v[236:239], v[152:155], v[212:215]
    v_mfma_f32_16x16x32_bf16 v[216:219], v[234:237], v[152:155], v[216:219]
    s_waitcnt vmcnt(10)
    s_barrier
    s_add_u32 m0, s50, 81920
    s_nop 0
    buffer_load_dwordx4 v10, s[24:27], s47 offen lds
    s_add_u32 m0, s50, 82944
    s_nop 0
    buffer_load_dwordx4 v11, s[24:27], s47 offen lds
    s_add_u32 m0, s50, 83968
    s_nop 0
    buffer_load_dwordx4 v12, s[24:27], s47 offen lds
    s_add_u32 m0, s50, 84992
    s_nop 0
    buffer_load_dwordx4 v13, s[24:27], s47 offen lds
    s_add_u32 m0, s51, 81920
    s_nop 0
    buffer_load_dwordx4 v14, s[28:31], s48 offen lds
    s_add_u32 m0, s51, 82944
    s_nop 0
    buffer_load_dwordx4 v15, s[28:31], s48 offen lds
    s_add_u32 m0, s51, 90112
    s_nop 0
    buffer_load_dwordx4 v16, s[28:31], s48 offen lds
    s_add_u32 m0, s51, 91136
    s_nop 0
    buffer_load_dwordx4 v17, s[28:31], s48 offen lds
    s_add_u32 m0, s51, 98304
    s_nop 0
    buffer_load_dwordx4 v18, s[28:31], s48 offen lds
    s_add_u32 m0, s51, 99328
    s_nop 0
    buffer_load_dwordx4 v19, s[28:31], s48 offen lds
    s_add_u32 s54, s54, 1
    s_and_b32 s54, s54, 15
    s_lshl_b32 s47, s54, 7
    s_mul_i32 s48, s54, 393216
    v_cvt_pk_bf16_f32 v100, v164, v180
    v_cvt_pk_bf16_f32 v101, v196, v212
    v_cvt_pk_bf16_f32 v102, v168, v184
    v_cvt_pk_bf16_f32 v103, v200, v216
    v_xor_b32 v102, s74, v102
    v_xor_b32 v103, s74, v103
    ds_write_b128 v26, v[100:103]
    v_cvt_pk_bf16_f32 v104, v165, v181
    v_cvt_pk_bf16_f32 v105, v197, v213
    v_cvt_pk_bf16_f32 v106, v169, v185
    v_cvt_pk_bf16_f32 v107, v201, v217
    v_xor_b32 v106, s74, v106
    v_xor_b32 v107, s74, v107
    ds_write_b128 v27, v[104:107]
    v_cvt_pk_bf16_f32 v108, v166, v182
    v_cvt_pk_bf16_f32 v109, v198, v214
    v_cvt_pk_bf16_f32 v110, v170, v186
    v_cvt_pk_bf16_f32 v111, v202, v218
    v_xor_b32 v110, s74, v110
    v_xor_b32 v111, s74, v111
    ds_write_b128 v28, v[108:111]
    v_cvt_pk_bf16_f32 v112, v167, v183
    v_cvt_pk_bf16_f32 v113, v199, v215
    v_cvt_pk_bf16_f32 v114, v171, v187
    v_cvt_pk_bf16_f32 v115, v203, v219
    v_xor_b32 v114, s74, v114
    v_xor_b32 v115, s74, v115
    ds_write_b128 v29, v[112:115]
    s_mov_b64 exec, 1
    ds_write_b32 v23, v20 offset:0
    s_mov_b64 exec, -1
    s_mov_b32 s60, s12
    s_mov_b32 s61, s13
    s_mov_b32 s62, 2101248
    s_mov_b32 s63, 0x00020000
    s_mov_b32 s64, s14
    s_mov_b32 s65, s15
    s_mov_b32 s66, 2101248
    s_mov_b32 s67, 0x00020000
    s_lshl_b32 s42, s40, 7
    s_lshl_b32 s43, s53, 3
    s_add_u32 s42, s42, s43
    v_lshrrev_b32 v210, 3, v0
    v_add_u32 v210, s42, v210
    s_movk_i32 s43, 1026
    v_mul_lo_u32 v210, v210, s43
    v_and_b32 v211, 7, v0
    v_lshlrev_b32 v211, 3, v211
    s_lshl_b32 s44, s41, 6
    v_add3_u32 v211, v210, v211, s44
    s_mov_b32 s80, 0
    s_mov_b32 s81, 32832
    s_mov_b32 s82, 65664
    s_mov_b32 s83, 98496
    buffer_load_dwordx2 v[164:165], v211, s[60:63], s80 offen
    buffer_load_dwordx2 v[172:173], v211, s[64:67], s80 offen
    buffer_load_dwordx2 v[166:167], v211, s[60:63], s81 offen
    buffer_load_dwordx2 v[174:175], v211, s[64:67], s81 offen
    buffer_load_dwordx2 v[168:169], v211, s[60:63], s82 offen
    buffer_load_dwordx2 v[176:177], v211, s[64:67], s82 offen
    buffer_load_dwordx2 v[170:171], v211, s[60:63], s83 offen
    buffer_load_dwordx2 v[178:179], v211, s[64:67], s83 offen
    s_cmp_lg_u32 s41, 15
    s_cbranch_scc1 L_no512_29
    v_and_b32 v212, 7, v0
    v_add_u32 v212, s42, v212
    v_mul_lo_u32 v212, v212, s43
    v_add_u32 v212, 1024, v212
    buffer_load_ushort v180, v212, s[60:63], s80 offen
    buffer_load_ushort v184, v212, s[64:67], s80 offen
    buffer_load_ushort v181, v212, s[60:63], s81 offen
    buffer_load_ushort v185, v212, s[64:67], s81 offen
    buffer_load_ushort v182, v212, s[60:63], s82 offen
    buffer_load_ushort v186, v212, s[64:67], s82 offen
    buffer_load_ushort v183, v212, s[60:63], s83 offen
    buffer_load_ushort v187, v212, s[64:67], s83 offen
L_no512_29:
    s_waitcnt vmcnt(18)
    s_barrier
    s_add_u32 m0, s50, 0
    s_nop 0
    buffer_load_dwordx4 v10, s[24:27], s47 offen lds
    s_add_u32 m0, s50, 1024
    s_nop 0
    buffer_load_dwordx4 v11, s[24:27], s47 offen lds
    s_add_u32 m0, s50, 2048
    s_nop 0
    buffer_load_dwordx4 v12, s[24:27], s47 offen lds
    s_add_u32 m0, s50, 3072
    s_nop 0
    buffer_load_dwordx4 v13, s[24:27], s47 offen lds
    s_add_u32 m0, s51, 0
    s_nop 0
    buffer_load_dwordx4 v14, s[28:31], s48 offen lds
    s_add_u32 m0, s51, 1024
    s_nop 0
    buffer_load_dwordx4 v15, s[28:31], s48 offen lds
    s_add_u32 m0, s51, 8192
    s_nop 0
    buffer_load_dwordx4 v16, s[28:31], s48 offen lds
    s_add_u32 m0, s51, 9216
    s_nop 0
    buffer_load_dwordx4 v17, s[28:31], s48 offen lds
    s_add_u32 m0, s51, 16384
    s_nop 0
    buffer_load_dwordx4 v18, s[28:31], s48 offen lds
    s_add_u32 m0, s51, 17408
    s_nop 0
    buffer_load_dwordx4 v19, s[28:31], s48 offen lds
    s_add_u32 s54, s54, 1
    s_and_b32 s54, s54, 15
    s_lshl_b32 s47, s54, 7
    s_mul_i32 s48, s54, 393216
    s_mov_b32 s57, 1048576
L_lw_30:
    ds_read_b32 v84, v22 offset:0
    s_waitcnt lgkmcnt(0)
    v_cmp_ne_u32 vcc, s56, v84
    s_cbranch_vccz L_lwd_31
    s_sub_u32 s57, s57, 1
    s_cmp_lg_u32 s57, 0
    s_cbranch_scc1 L_lw_30
L_lwd_31:
    s_lshl_b32 s75, s53, 6
    v_add_u32 v25, s75, v0
    v_lshlrev_b32 v24, 4, v25
    v_and_b32 v29, 3, v25
    v_lshrrev_b32 v25, 2, v25
    v_mul_u32_u24 v25, 16512, v25
    v_lshl_add_u32 v25, v29, 4, v25
    v_add_u32 v24, 139264, v24
    ds_read_b128 v[100:103], v24 offset:0
    ds_read_b128 v[104:107], v24 offset:4096
    ds_read_b128 v[108:111], v24 offset:8192
    ds_read_b128 v[112:115], v24 offset:12288
    s_lshl_b32 s75, s2, 6
    s_add_u32 s75, s75, 16777216
    s_waitcnt lgkmcnt(3)
    buffer_store_dwordx4 v[100:103], v25, s[32:35], s75 offen sc1
    s_add_u32 s75, s75, 1056768
    s_waitcnt lgkmcnt(2)
    buffer_store_dwordx4 v[104:107], v25, s[32:35], s75 offen sc1
    s_add_u32 s75, s75, 1056768
    s_waitcnt lgkmcnt(1)
    buffer_store_dwordx4 v[108:111], v25, s[32:35], s75 offen sc1
    s_add_u32 s75, s75, 1056768
    s_waitcnt lgkmcnt(0)
    buffer_store_dwordx4 v[112:115], v25, s[32:35], s75 offen sc1
    s_waitcnt vmcnt(22)
    s_barrier
    s_add_u32 m0, s50, 40960
    s_nop 0
    buffer_load_dwordx4 v10, s[24:27], s47 offen lds
    s_add_u32 m0, s50, 41984
    s_nop 0
    buffer_load_dwordx4 v11, s[24:27], s47 offen lds
    s_add_u32 m0, s50, 43008
    s_nop 0
    buffer_load_dwordx4 v12, s[24:27], s47 offen lds
    s_add_u32 m0, s50, 44032
    s_nop 0
    buffer_load_dwordx4 v13, s[24:27], s47 offen lds
    s_add_u32 m0, s51, 40960
    s_nop 0
    buffer_load_dwordx4 v14, s[28:31], s48 offen lds
    s_add_u32 m0, s51, 41984
    s_nop 0
    buffer_load_dwordx4 v15, s[28:31], s48 offen lds
    s_add_u32 m0, s51, 49152
    s_nop 0
    buffer_load_dwordx4 v16, s[28:31], s48 offen lds
    s_add_u32 m0, s51, 50176
    s_nop 0
    buffer_load_dwordx4 v17, s[28:31], s48 offen lds
    s_add_u32 m0, s51, 57344
    s_nop 0
    buffer_load_dwordx4 v18, s[28:31], s48 offen lds
    s_add_u32 m0, s51, 58368
    s_nop 0
    buffer_load_dwordx4 v19, s[28:31], s48 offen lds
    s_add_u32 s54, s54, 1
    s_and_b32 s54, s54, 15
    s_lshl_b32 s47, s54, 7
    s_mul_i32 s48, s54, 393216
    s_waitcnt vmcnt(23)
    s_mov_b32 s84, 0x05040100
    s_mov_b32 s85, 0x07060302
    s_lshl_b32 s42, s53, 10
    s_add_u32 s42, s42, 155648
    v_lshrrev_b32 v207, 3, v0
    v_and_b32 v208, 7, v0
    v_xor_b32 v209, v207, v208
    v_lshlrev_b32 v209, 4, v209
    v_lshl_add_u32 v204, v208, 7, v209
    v_add_u32 v204, s42, v204
    v_lshl_add_u32 v205, v207, 7, v209
    v_add_u32 v205, s42, v205
    v_perm_b32 v188, v166, v164, s84
    v_perm_b32 v189, v170, v168, s84
    v_perm_b32 v190, v174, v172, s84
    v_perm_b32 v191, v178, v176, s84
    v_perm_b32 v192, v166, v164, s85
    v_perm_b32 v193, v170, v168, s85
    v_perm_b32 v194, v174, v172, s85
    v_perm_b32 v195, v178, v176, s85
    v_perm_b32 v196, v167, v165, s84
    v_perm_b32 v197, v171, v169, s84
    v_perm_b32 v198, v175, v173, s84
    v_perm_b32 v199, v179, v177, s84
    v_perm_b32 v200, v167, v165, s85
    v_perm_b32 v201, v171, v169, s85
    v_perm_b32 v202, v175, v173, s85
    v_perm_b32 v203, v179, v177, s85
    ds_write_b128 v204, v[188:191]
    ds_read_b128 v[164:167], v205
    ds_write_b128 v204, v[192:195]
    ds_read_b128 v[168:171], v205
    ds_write_b128 v204, v[196:199]
    ds_read_b128 v[172:175], v205
    ds_write_b128 v204, v[200:203]
    ds_read_b128 v[176:179], v205
    s_mov_b32 s43, 33280
    v_mul_lo_u32 v206, v207, s43
    v_lshl_add_u32 v206, v208, 4, v206
    s_mul_i32 s42, s41, 266240
    s_lshl_b32 s43, s40, 9
    s_add_u32 s42, s42, s43
    s_lshl_b32 s43, s53, 7
    s_add_u32 s42, s42, s43
    s_add_u32 s42, s42, 8388608
    s_waitcnt lgkmcnt(6)
    buffer_store_dwordx4 v[164:167], v206, s[32:35], s42 offen sc1
    s_add_u32 s42, s42, 8320
    s_waitcnt lgkmcnt(4)
    buffer_store_dwordx4 v[168:171], v206, s[32:35], s42 offen sc1
    s_add_u32 s42, s42, 8320
    s_waitcnt lgkmcnt(2)
    buffer_store_dwordx4 v[172:175], v206, s[32:35], s42 offen sc1
    s_add_u32 s42, s42, 8320
    s_waitcnt lgkmcnt(0)
    buffer_store_dwordx4 v[176:179], v206, s[32:35], s42 offen sc1
    s_cmp_lg_u32 s41, 15
    s_cbranch_scc1 L_no512b_32
    v_perm_b32 v188, v181, v180, s84
    v_perm_b32 v189, v183, v182, s84
    v_perm_b32 v190, v185, v184, s84
    v_perm_b32 v191, v187, v186, s84
    v_lshlrev_b32 v206, 4, v208
    s_lshl_b32 s42, s40, 9
    s_lshl_b32 s43, s53, 7
    s_add_u32 s42, s42, s43
    s_add_u32 s42, s42, 12648448
    s_mov_b64 exec, 0xff
    buffer_store_dwordx4 v[188:191], v206, s[32:35], s42 offen sc1
    s_mov_b64 exec, -1
L_no512b_32:
    s_waitcnt vmcnt(18)
    s_barrier
    s_add_u32 m0, s50, 81920
    s_nop 0
    buffer_load_dwordx4 v10, s[24:27], s47 offen lds
    s_add_u32 m0, s50, 82944
    s_nop 0
    buffer_load_dwordx4 v11, s[24:27], s47 offen lds
    s_add_u32 m0, s50, 83968
    s_nop 0
    buffer_load_dwordx4 v12, s[24:27], s47 offen lds
    s_add_u32 m0, s50, 84992
    s_nop 0
    buffer_load_dwordx4 v13, s[24:27], s47 offen lds
    s_add_u32 m0, s51, 81920
    s_nop 0
    buffer_load_dwordx4 v14, s[28:31], s48 offen lds
    s_add_u32 m0, s51, 82944
    s_nop 0
    buffer_load_dwordx4 v15, s[28:31], s48 offen lds
    s_add_u32 m0, s51, 90112
    s_nop 0
    buffer_load_dwordx4 v16, s[28:31], s48 offen lds
    s_add_u32 m0, s51, 91136
    s_nop 0
    buffer_load_dwordx4 v17, s[28:31], s48 offen lds
    s_add_u32 m0, s51, 98304
    s_nop 0
    buffer_load_dwordx4 v18, s[28:31], s48 offen lds
    s_add_u32 m0, s51, 99328
    s_nop 0
    buffer_load_dwordx4 v19, s[28:31], s48 offen lds
    s_add_u32 s54, s54, 1
    s_and_b32 s54, s54, 15
    s_lshl_b32 s47, s54, 7
    s_mul_i32 s48, s54, 393216
    s_waitcnt vmcnt(24)
    v_mov_b32 v212, 1
    s_mov_b64 exec, 1
    ds_add_rtn_u32 v213, v22, v212 offset:16
    s_waitcnt lgkmcnt(0)
    v_readfirstlane_b32 s75, v213
    s_mov_b64 exec, -1
    s_cmp_lg_u32 s75, 3
    s_cbranch_scc1 L_lf_33
    s_lshl_b32 s75, s2, 2
    s_add_u32 s75, s75, 16384
    s_mov_b64 exec, 1
    buffer_store_dword v20, v21, s[32:35], s75 offen sc1
    s_mov_b64 exec, -1
L_lf_33:
    s_waitcnt vmcnt(14)
    s_barrier
    s_add_u32 m0, s50, 0
    s_nop 0
    buffer_load_dwordx4 v10, s[24:27], s47 offen lds
    s_add_u32 m0, s50, 1024
    s_nop 0
    buffer_load_dwordx4 v11, s[24:27], s47 offen lds
    s_add_u32 m0, s50, 2048
    s_nop 0
    buffer_load_dwordx4 v12, s[24:27], s47 offen lds
    s_add_u32 m0, s50, 3072
    s_nop 0
    buffer_load_dwordx4 v13, s[24:27], s47 offen lds
    s_add_u32 m0, s51, 0
    s_nop 0
    buffer_load_dwordx4 v14, s[28:31], s48 offen lds
    s_add_u32 m0, s51, 1024
    s_nop 0
    buffer_load_dwordx4 v15, s[28:31], s48 offen lds
    s_add_u32 m0, s51, 8192
    s_nop 0
    buffer_load_dwordx4 v16, s[28:31], s48 offen lds
    s_add_u32 m0, s51, 9216
    s_nop 0
    buffer_load_dwordx4 v17, s[28:31], s48 offen lds
    s_add_u32 m0, s51, 16384
    s_nop 0
    buffer_load_dwordx4 v18, s[28:31], s48 offen lds
    s_add_u32 m0, s51, 17408
    s_nop 0
    buffer_load_dwordx4 v19, s[28:31], s48 offen lds
    s_add_u32 s54, s54, 1
    s_and_b32 s54, s54, 15
    s_lshl_b32 s47, s54, 7
    s_mul_i32 s48, s54, 393216
    s_waitcnt vmcnt(19)
    s_lshl_b32 s42, s41, 4
    s_add_u32 s42, s42, s40
    s_lshl_b32 s42, s42, 2
    s_add_u32 s42, s42, s53
    s_lshl_b32 s42, s42, 2
    s_add_u32 s42, s42, 12288
    s_mov_b64 exec, 1
    buffer_store_dword v20, v21, s[32:35], s42 offen sc1
    s_mov_b64 exec, -1
    s_waitcnt vmcnt(10)
    s_barrier
    s_add_u32 m0, s50, 40960
    s_nop 0
    buffer_load_dwordx4 v10, s[24:27], s47 offen lds
    s_add_u32 m0, s50, 41984
    s_nop 0
    buffer_load_dwordx4 v11, s[24:27], s47 offen lds
    s_add_u32 m0, s50, 43008
    s_nop 0
    buffer_load_dwordx4 v12, s[24:27], s47 offen lds
    s_add_u32 m0, s50, 44032
    s_nop 0
    buffer_load_dwordx4 v13, s[24:27], s47 offen lds
    s_add_u32 m0, s51, 40960
    s_nop 0
    buffer_load_dwordx4 v14, s[28:31], s48 offen lds
    s_add_u32 m0, s51, 41984
    s_nop 0
    buffer_load_dwordx4 v15, s[28:31], s48 offen lds
    s_add_u32 m0, s51, 49152
    s_nop 0
    buffer_load_dwordx4 v16, s[28:31], s48 offen lds
    s_add_u32 m0, s51, 50176
    s_nop 0
    buffer_load_dwordx4 v17, s[28:31], s48 offen lds
    s_add_u32 m0, s51, 57344
    s_nop 0
    buffer_load_dwordx4 v18, s[28:31], s48 offen lds
    s_add_u32 m0, s51, 58368
    s_nop 0
    buffer_load_dwordx4 v19, s[28:31], s48 offen lds
    s_add_u32 s54, s54, 1
    s_and_b32 s54, s54, 15
    s_lshl_b32 s47, s54, 7
    s_mul_i32 s48, s54, 393216
    s_lshl_b32 s75, s72, 4
    v_cvt_f32_u32 v160, s75
    v_add_f32 v152, v160, v240
    v_add_f32 v153, v160, v241
    v_add_f32 v154, v160, v242
    v_add_f32 v155, v160, v243
    v_add_f32 v160, 0, v248
    v_mul_f32 v160, 0x3a800000, v160
    v_mul_f32 v148, v152, v160
    v_mul_f32 v149, v153, v160
    v_mul_f32 v150, v154, v160
    v_mul_f32 v151, v155, v160
    v_cos_f32 v84, v148
    v_cos_f32 v85, v149
    v_cos_f32 v86, v150
    v_cos_f32 v87, v151
    v_sin_f32 v88, v148
    v_sin_f32 v89, v149
    v_sin_f32 v90, v150
    v_sin_f32 v91, v151
    v_add_f32 v160, 0x41800000, v248
    v_mul_f32 v160, 0x3a800000, v160
    v_mul_f32 v148, v152, v160
    v_mul_f32 v149, v153, v160
    v_mul_f32 v150, v154, v160
    v_mul_f32 v151, v155, v160
    v_cos_f32 v92, v148
    v_cos_f32 v93, v149
    v_cos_f32 v94, v150
    v_cos_f32 v95, v151
    v_sin_f32 v96, v148
    v_sin_f32 v97, v149
    v_sin_f32 v98, v150
    v_sin_f32 v99, v151
    s_waitcnt vmcnt(10)
    s_barrier
    s_add_u32 m0, s50, 81920
    s_nop 0
    buffer_load_dwordx4 v10, s[24:27], s47 offen lds
    s_add_u32 m0, s50, 82944
    s_nop 0
    buffer_load_dwordx4 v11, s[24:27], s47 offen lds
    s_add_u32 m0, s50, 83968
    s_nop 0
    buffer_load_dwordx4 v12, s[24:27], s47 offen lds
    s_add_u32 m0, s50, 84992
    s_nop 0
    buffer_load_dwordx4 v13, s[24:27], s47 offen lds
    s_add_u32 m0, s51, 81920
    s_nop 0
    buffer_load_dwordx4 v14, s[28:31], s48 offen lds
    s_add_u32 m0, s51, 82944
    s_nop 0
    buffer_load_dwordx4 v15, s[28:31], s48 offen lds
    s_add_u32 m0, s51, 90112
    s_nop 0
    buffer_load_dwordx4 v16, s[28:31], s48 offen lds
    s_add_u32 m0, s51, 91136
    s_nop 0
    buffer_load_dwordx4 v17, s[28:31], s48 offen lds
    s_add_u32 m0, s51, 98304
    s_nop 0
    buffer_load_dwordx4 v18, s[28:31], s48 offen lds
    s_add_u32 m0, s51, 99328
    s_nop 0
    buffer_load_dwordx4 v19, s[28:31], s48 offen lds
    s_add_u32 s54, s54, 1
    s_and_b32 s54, s54, 15
    s_lshl_b32 s47, s54, 7
    s_mul_i32 s48, s54, 393216
    s_mov_b32 s60, s8
    s_mov_b32 s61, s9
    s_mov_b32 s62, 2097152
    s_mov_b32 s63, 0x00020000
    v_lshrrev_b32 v252, 3, v0
    v_and_b32 v253, 7, v0
    v_bfe_u32 v254, v0, 4, 2
    v_lshlrev_b32 v254, 1, v254
    v_xor_b32 v253, v253, v254
    v_lshlrev_b32 v253, 4, v253
    v_lshl_add_u32 v252, v252, 11, v253
    s_lshl_b32 s87, s53, 14
    s_lshl_b32 s77, s71, 7
    s_add_u32 s87, s87, s77
    s_lshl_b32 s75, s53, 10
    s_add_u32 m0, s75, 122880
    s_add_u32 s76, s87, 1966080
    buffer_load_dwordx4 v252, s[60:63], s76 offen lds
    s_add_u32 m0, s75, 126976
    s_add_u32 s76, s87, 2031616
    buffer_load_dwordx4 v252, s[60:63], s76 offen lds
    s_waitcnt vmcnt(12)
    s_barrier
    s_add_u32 m0, s50, 0
    s_nop 0
    buffer_load_dwordx4 v10, s[24:27], s47 offen lds
    s_add_u32 m0, s50, 1024
    s_nop 0
    buffer_load_dwordx4 v11, s[24:27], s47 offen lds
    s_add_u32 m0, s50, 2048
    s_nop 0
    buffer_load_dwordx4 v12, s[24:27], s47 offen lds
    s_add_u32 m0, s50, 3072
    s_nop 0
    buffer_load_dwordx4 v13, s[24:27], s47 offen lds
    s_add_u32 m0, s51, 0
    s_nop 0
    buffer_load_dwordx4 v14, s[28:31], s48 offen lds
    s_add_u32 m0, s51, 1024
    s_nop 0
    buffer_load_dwordx4 v15, s[28:31], s48 offen lds
    s_add_u32 m0, s51, 8192
    s_nop 0
    buffer_load_dwordx4 v16, s[28:31], s48 offen lds
    s_add_u32 m0, s51, 9216
    s_nop 0
    buffer_load_dwordx4 v17, s[28:31], s48 offen lds
    s_add_u32 m0, s51, 16384
    s_nop 0
    buffer_load_dwordx4 v18, s[28:31], s48 offen lds
    s_add_u32 m0, s51, 17408
    s_nop 0
    buffer_load_dwordx4 v19, s[28:31], s48 offen lds
    v_lshlrev_b32 v232, 4, v0
    s_mov_b32 s75, 16384
    buffer_load_dwordx4 v[228:231], v232, s[32:35], s75 offen sc1
    v_lshlrev_b32 v3, 2, v0
    s_lshr_b32 s75, s2, 4
    s_lshl_b32 s75, s75, 8
    s_add_u32 s78, s75, 12288
    s_cmp_eq_u32 s2, 0
    s_cselect_b32 s86, 16128, s78
    buffer_load_dword v1, v3, s[32:35], s78 offen sc1
    buffer_load_dword v2, v3, s[32:35], s86 offen sc1
    s_waitcnt vmcnt(15)
    s_barrier
    s_lshl_b32 s75, s53, 10
    s_add_u32 m0, s75, 40960
    s_add_u32 s76, s87, 655360
    buffer_load_dwordx4 v252, s[60:63], s76 offen lds
    s_add_u32 m0, s75, 45056
    s_add_u32 s76, s87, 720896
    buffer_load_dwordx4 v252, s[60:63], s76 offen lds
    s_add_u32 m0, s75, 49152
    s_add_u32 s76, s87, 786432
    buffer_load_dwordx4 v252, s[60:63], s76 offen lds
    s_add_u32 m0, s75, 53248
    s_add_u32 s76, s87, 851968
    buffer_load_dwordx4 v252, s[60:63], s76 offen lds
    s_add_u32 m0, s75, 57344
    s_add_u32 s76, s87, 917504
    buffer_load_dwordx4 v252, s[60:63], s76 offen lds
    s_add_u32 m0, s75, 61440
    s_add_u32 s76, s87, 983040
    buffer_load_dwordx4 v252, s[60:63], s76 offen lds
    s_add_u32 m0, s75, 65536
    s_add_u32 s76, s87, 1048576
    buffer_load_dwordx4 v252, s[60:63], s76 offen lds
    s_add_u32 m0, s75, 69632
    s_add_u32 s76, s87, 1114112
    buffer_load_dwordx4 v252, s[60:63], s76 offen lds
    s_add_u32 m0, s75, 73728
    s_add_u32 s76, s87, 1179648
    buffer_load_dwordx4 v252, s[60:63], s76 offen lds
    s_add_u32 m0, s75, 77824
    s_add_u32 s76, s87, 1245184
    buffer_load_dwordx4 v252, s[60:63], s76 offen lds
    s_waitcnt vmcnt(13)
    s_barrier
    s_lshl_b32 s75, s53, 6
    v_add_u32 v25, s75, v0
    v_lshrrev_b32 v24, 4, v25
    v_xor_b32 v24, v24, v25
    v_and_b32 v24, 3, v24
    v_lshlrev_b32 v24, 4, v24
    v_and_b32 v29, 0xfc, v25
    v_lshl_add_u32 v24, v29, 4, v24
    v_and_b32 v29, 3, v25
    v_lshrrev_b32 v25, 2, v25
    v_mul_u32_u24 v25, 16512, v25
    v_lshl_add_u32 v25, v29, 4, v25
    v_add_u32 v24, 131072, v24
    s_lshl_b32 s76, s53, 6
    v_add_u32 v25, s76, v0
    v_lshlrev_b32 v25, 4, v25
    s_waitcnt vmcnt(10)
    v_xor_b32 v228, s56, v228
    v_xor_b32 v229, s56, v229
    v_xor_b32 v230, s56, v230
    v_xor_b32 v231, s56, v231
    v_or3_b32 v228, v228, v229, v230
    v_or_b32 v228, v228, v231
    v_cmp_ne_u32 vcc, 0, v228
    s_mov_b32 s88, 1
    s_cbranch_vccnz L_slow_34
    s_mov_b32 s88, 0
    s_mul_i32 s75, s2, 16512
    s_add_u32 s75, s75, 16777216
    buffer_load_dwordx4 v[148:151], v25, s[32:35], s75 offen sc1
    s_add_u32 s75, s75, 4096
    buffer_load_dwordx4 v[152:155], v25, s[32:35], s75 offen sc1
    s_add_u32 s75, s75, 4096
    buffer_load_dwordx4 v[156:159], v25, s[32:35], s75 offen sc1
    s_add_u32 s75, s75, 4096
    buffer_load_dwordx4 v[160:163], v25, s[32:35], s75 offen sc1
L_slow_34:
    v_xor_b32 v1, s56, v1
    v_xor_b32 v2, s56, v2
    v_or_b32 v1, v1, v2
    v_cmp_ne_u32 vcc, 0, v1
    s_mov_b32 s89, 1
    s_cbranch_vccnz L_sloww_35
    s_mov_b32 s89, 0
    s_lshl_b32 s85, s2, 1
    s_add_u32 s85, s85, s73
    s_mul_i32 s75, s85, 8320
    s_add_u32 s75, s75, 8388608
    s_add_u32 s76, s75, 4096
    v_lshrrev_b32 v26, 4, v0
    v_lshlrev_b32 v26, 9, v26
    v_and_b32 v27, 15, v0
    v_lshl_add_u32 v26, v27, 4, v26
    s_lshl_b32 s77, s72, 8
    v_add_u32 v26, s77, v26
    buffer_load_dwordx4 v[180:183], v26, s[32:35], s75 offen offset:0 sc1
    buffer_load_dwordx4 v[184:187], v26, s[32:35], s76 offen offset:0 sc1
    buffer_load_dwordx4 v[188:191], v26, s[32:35], s75 offen offset:2048 sc1
    buffer_load_dwordx4 v[192:195], v26, s[32:35], s76 offen offset:2048 sc1
    s_cmp_lg_u32 s2, 0
    s_cbranch_scc1 L_n0_36
    s_movk_i32 s85, 512
    s_mul_i32 s75, s85, 8320
    s_add_u32 s75, s75, 8388608
    s_add_u32 s76, s75, 4096
    v_lshrrev_b32 v26, 4, v0
    v_lshlrev_b32 v26, 9, v26
    v_and_b32 v27, 15, v0
    v_lshl_add_u32 v26, v27, 4, v26
    s_lshl_b32 s77, s72, 8
    v_add_u32 v26, s77, v26
    buffer_load_dwordx4 v[4:7], v26, s[32:35], s75 offen offset:0 sc1
    buffer_load_dwordx4 v[8:11], v26, s[32:35], s76 offen offset:0 sc1
    buffer_load_dwordx4 v[12:15], v26, s[32:35], s75 offen offset:2048 sc1
    buffer_load_dwordx4 v[16:19], v26, s[32:35], s76 offen offset:2048 sc1
L_n0_36:
L_sloww_35:
    s_lshl_b32 s75, s53, 10
    s_add_u32 m0, s75, 81920
    s_add_u32 s76, s87, 1310720
    buffer_load_dwordx4 v252, s[60:63], s76 offen lds
    s_add_u32 m0, s75, 86016
    s_add_u32 s76, s87, 1376256
    buffer_load_dwordx4 v252, s[60:63], s76 offen lds
    s_add_u32 m0, s75, 90112
    s_add_u32 s76, s87, 1441792
    buffer_load_dwordx4 v252, s[60:63], s76 offen lds
    s_add_u32 m0, s75, 94208
    s_add_u32 s76, s87, 1507328
    buffer_load_dwordx4 v252, s[60:63], s76 offen lds
    s_add_u32 m0, s75, 98304
    s_add_u32 s76, s87, 1572864
    buffer_load_dwordx4 v252, s[60:63], s76 offen lds
    s_add_u32 m0, s75, 102400
    s_add_u32 s76, s87, 1638400
    buffer_load_dwordx4 v252, s[60:63], s76 offen lds
    s_add_u32 m0, s75, 106496
    s_add_u32 s76, s87, 1703936
    buffer_load_dwordx4 v252, s[60:63], s76 offen lds
    s_add_u32 m0, s75, 110592
    s_add_u32 s76, s87, 1769472
    buffer_load_dwordx4 v252, s[60:63], s76 offen lds
    s_add_u32 m0, s75, 114688
    s_add_u32 s76, s87, 1835008
    buffer_load_dwordx4 v252, s[60:63], s76 offen lds
    s_add_u32 m0, s75, 118784
    s_add_u32 s76, s87, 1900544
    buffer_load_dwordx4 v252, s[60:63], s76 offen lds
    s_barrier
    s_setprio 0
    s_cmp_eq_u32 s88, 0
    s_cbranch_scc1 L_fast_37
    s_mov_b32 s75, 16384
    s_mov_b32 s57, 1048576
L_poll_39:
    buffer_load_dwordx4 v[228:231], v232, s[32:35], s75 offen sc1
    s_waitcnt vmcnt(0)
    v_xor_b32 v228, s56, v228
    v_xor_b32 v229, s56, v229
    v_xor_b32 v230, s56, v230
    v_xor_b32 v231, s56, v231
    v_or3_b32 v228, v228, v229, v230
    v_or_b32 v228, v228, v231
    v_cmp_ne_u32 vcc, 0, v228
    s_cbranch_vccz L_polld_40
    s_sub_u32 s57, s57, 1
    s_cmp_lg_u32 s57, 0
    s_cbranch_scc1 L_poll_39
L_polld_40:
    s_mul_i32 s75, s2, 16512
    s_add_u32 s75, s75, 16777216
    buffer_load_dwordx4 v[148:151], v25, s[32:35], s75 offen sc1
    s_add_u32 s75, s75, 4096
    buffer_load_dwordx4 v[152:155], v25, s[32:35], s75 offen sc1
    s_add_u32 s75, s75, 4096
    buffer_load_dwordx4 v[156:159], v25, s[32:35], s75 offen sc1
    s_add_u32 s75, s75, 4096
    buffer_load_dwordx4 v[160:163], v25, s[32:35], s75 offen sc1
    s_waitcnt vmcnt(0)
L_fast_37:
    s_cmp_eq_u32 s89, 0
    s_cbranch_scc1 L_fastw_38
    s_mov_b32 s57, 1048576
L_poll_41:
    buffer_load_dword v1, v3, s[32:35], s78 offen sc1
    s_waitcnt vmcnt(0)
    v_cmp_ne_u32 vcc, s56, v1
    s_cbranch_vccz L_polld_42
    s_sub_u32 s57, s57, 1
    s_cmp_lg_u32 s57, 0
    s_cbranch_scc1 L_poll_41
L_polld_42:
    s_mov_b32 s57, 1048576
L_poll_43:
    buffer_load_dword v1, v3, s[32:35], s86 offen sc1
    s_waitcnt vmcnt(0)
    v_cmp_ne_u32 vcc, s56, v1
    s_cbranch_vccz L_polld_44
    s_sub_u32 s57, s57, 1
    s_cmp_lg_u32 s57, 0
    s_cbranch_scc1 L_poll_43
L_polld_44:
    s_lshl_b32 s85, s2, 1
    s_add_u32 s85, s85, s73
    s_mul_i32 s75, s85, 8320
    s_add_u32 s75, s75, 8388608
    s_add_u32 s76, s75, 4096
    v_lshrrev_b32 v26, 4, v0
    v_lshlrev_b32 v26, 9, v26
    v_and_b32 v27, 15, v0
    v_lshl_add_u32 v26, v27, 4, v26
    s_lshl_b32 s77, s72, 8
    v_add_u32 v26, s77, v26
    buffer_load_dwordx4 v[180:183], v26, s[32:35], s75 offen offset:0 sc1
    buffer_load_dwordx4 v[184:187], v26, s[32:35], s76 offen offset:0 sc1
    buffer_load_dwordx4 v[188:191], v26, s[32:35], s75 offen offset:2048 sc1
    buffer_load_dwordx4 v[192:195], v26, s[32:35], s76 offen offset:2048 sc1
    s_cmp_lg_u32 s2, 0
    s_cbranch_scc1 L_n0_45
    s_movk_i32 s85, 512
    s_mul_i32 s75, s85, 8320
    s_add_u32 s75, s75, 8388608
    s_add_u32 s76, s75, 4096
    v_lshrrev_b32 v26, 4, v0
    v_lshlrev_b32 v26, 9, v26
    v_and_b32 v27, 15, v0
    v_lshl_add_u32 v26, v27, 4, v26
    s_lshl_b32 s77, s72, 8
    v_add_u32 v26, s77, v26
    buffer_load_dwordx4 v[4:7], v26, s[32:35], s75 offen offset:0 sc1
    buffer_load_dwordx4 v[8:11], v26, s[32:35], s76 offen offset:0 sc1
    buffer_load_dwordx4 v[12:15], v26, s[32:35], s75 offen offset:2048 sc1
    buffer_load_dwordx4 v[16:19], v26, s[32:35], s76 offen offset:2048 sc1
L_n0_45:
    s_waitcnt vmcnt(0)
L_fastw_38:
    s_mov_b32 s79, 0
    s_or_b32 s84, s2, s73
    v_lshrrev_b32 v26, 4, v0
    v_lshlrev_b32 v26, 11, v26
    v_and_b32 v27, 15, v0
    v_lshl_add_u32 v26, v27, 6, v26
    v_add_u32 v26, 131072, v26
    v_lshrrev_b32 v27, 2, v27
    v_xor_b32 v28, s73, v27
    v_lshl_add_u32 v28, v28, 4, v26
    s_add_u32 s75, s73, 2
    s_cmp_eq_u32 s84, 0
    s_cselect_b32 s75, 0, s75
    v_xor_b32 v29, s75, v27
    v_lshl_add_u32 v29, v29, 4, v26
    v_xor_b32 v27, 2, v27
    v_lshl_add_u32 v27, v27, 4, v26
    s_waitcnt vmcnt(13)
    ds_write_b128 v24, v[148:151] offset:0
    s_waitcnt vmcnt(12)
    ds_write_b128 v24, v[152:155] offset:4096
    s_waitcnt vmcnt(11)
    ds_write_b128 v24, v[156:159] offset:8192
    s_waitcnt vmcnt(10)
    ds_write_b128 v24, v[160:163] offset:12288
    s_mov_b64 exec, 1
    ds_write_b32 v23, v20 offset:48
    s_mov_b64 exec, -1
    s_waitcnt vmcnt(10) lgkmcnt(0)
    s_lshl_b32 s75, s72, 4
    v_cvt_f32_u32 v176, s75
    v_add_f32 v176, v176, v248
    v_mul_f32 v176, 0x3a000000, v176
    s_mov_b32 s76, 0x3c800000
    s_mov_b32 s77, 0xffff0000
    v_fma_f32 v172, v240, s76, v176
    v_fma_f32 v173, v241, s76, v176
    v_fma_f32 v174, v242, s76, v176
    v_fma_f32 v175, v243, s76, v176
    v_sin_f32 v164, v172
    v_sin_f32 v165, v173
    v_sin_f32 v166, v174
    v_sin_f32 v167, v175
    v_cos_f32 v168, v172
    v_cos_f32 v169, v173
    v_cos_f32 v170, v174
    v_cos_f32 v171, v175
    v_lshlrev_b32 v148, 16, v180
    v_and_b32 v149, s77, v180
    v_lshlrev_b32 v150, 16, v181
    v_and_b32 v151, s77, v181
    v_lshlrev_b32 v152, 16, v182
    v_and_b32 v153, s77, v182
    v_lshlrev_b32 v154, 16, v183
    v_and_b32 v155, s77, v183
    v_lshlrev_b32 v156, 16, v184
    v_and_b32 v157, s77, v184
    v_lshlrev_b32 v158, 16, v185
    v_and_b32 v159, s77, v185
    v_lshlrev_b32 v160, 16, v186
    v_and_b32 v161, s77, v186
    v_lshlrev_b32 v162, 16, v187
    v_and_b32 v163, s77, v187
    v_pk_add_f32 v[196:197], v[148:149], v[156:157]
    v_pk_add_f32 v[198:199], v[150:151], v[158:159]
    v_pk_add_f32 v[200:201], v[152:153], v[160:161]
    v_pk_add_f32 v[202:203], v[154:155], v[162:163]
    v_pk_add_f32 v[204:205], v[148:149], v[156:157] neg_lo:[0,1] neg_hi:[0,1]
    v_pk_add_f32 v[206:207], v[150:151], v[158:159] neg_lo:[0,1] neg_hi:[0,1]
    v_pk_add_f32 v[208:209], v[152:153], v[160:161] neg_lo:[0,1] neg_hi:[0,1]
    v_pk_add_f32 v[210:211], v[154:155], v[162:163] neg_lo:[0,1] neg_hi:[0,1]
    v_pk_fma_f32 v[100:101], v[164:165], v[204:205], v[196:197] neg_lo:[1,0,0] neg_hi:[1,0,0]
    v_pk_fma_f32 v[108:109], v[164:165], v[204:205], v[196:197]
    v_pk_mul_f32 v[116:117], v[168:169], v[204:205]
    v_pk_fma_f32 v[102:103], v[166:167], v[206:207], v[198:199] neg_lo:[1,0,0] neg_hi:[1,0,0]
    v_pk_fma_f32 v[110:111], v[166:167], v[206:207], v[198:199]
    v_pk_mul_f32 v[118:119], v[170:171], v[206:207]
    v_pk_fma_f32 v[104:105], v[164:165], v[208:209], v[200:201] neg_lo:[1,0,0] neg_hi:[1,0,0]
    v_pk_fma_f32 v[112:113], v[164:165], v[208:209], v[200:201]
    v_pk_mul_f32 v[120:121], v[168:169], v[208:209]
    v_pk_fma_f32 v[106:107], v[166:167], v[210:211], v[202:203] neg_lo:[1,0,0] neg_hi:[1,0,0]
    v_pk_fma_f32 v[114:115], v[166:167], v[210:211], v[202:203]
    v_pk_mul_f32 v[122:123], v[170:171], v[210:211]
    v_fma_f32 v172, v244, s76, v176
    v_fma_f32 v173, v245, s76, v176
    v_fma_f32 v174, v246, s76, v176
    v_fma_f32 v175, v247, s76, v176
    v_sin_f32 v164, v172
    v_sin_f32 v165, v173
    v_sin_f32 v166, v174
    v_sin_f32 v167, v175
    v_cos_f32 v168, v172
    v_cos_f32 v169, v173
    v_cos_f32 v170, v174
    v_cos_f32 v171, v175
    v_lshlrev_b32 v148, 16, v188
    v_and_b32 v149, s77, v188
    v_lshlrev_b32 v150, 16, v189
    v_and_b32 v151, s77, v189
    v_lshlrev_b32 v152, 16, v190
    v_and_b32 v153, s77, v190
    v_lshlrev_b32 v154, 16, v191
    v_and_b32 v155, s77, v191
    v_lshlrev_b32 v156, 16, v192
    v_and_b32 v157, s77, v192
    v_lshlrev_b32 v158, 16, v193
    v_and_b32 v159, s77, v193
    v_lshlrev_b32 v160, 16, v194
    v_and_b32 v161, s77, v194
    v_lshlrev_b32 v162, 16, v195
    v_and_b32 v163, s77, v195
    v_pk_add_f32 v[196:197], v[148:149], v[156:157]
    v_pk_add_f32 v[198:199], v[150:151], v[158:159]
    v_pk_add_f32 v[200:201], v[152:153], v[160:161]
    v_pk_add_f32 v[202:203], v[154:155], v[162:163]
    v_pk_add_f32 v[204:205], v[148:149], v[156:157] neg_lo:[0,1] neg_hi:[0,1]
    v_pk_add_f32 v[206:207], v[150:151], v[158:159] neg_lo:[0,1] neg_hi:[0,1]
    v_pk_add_f32 v[208:209], v[152:153], v[160:161] neg_lo:[0,1] neg_hi:[0,1]
    v_pk_add_f32 v[210:211], v[154:155], v[162:163] neg_lo:[0,1] neg_hi:[0,1]
    v_pk_fma_f32 v[124:125], v[164:165], v[204:205], v[196:197] neg_lo:[1,0,0] neg_hi:[1,0,0]
    v_pk_fma_f32 v[132:133], v[164:165], v[204:205], v[196:197]
    v_pk_mul_f32 v[140:141], v[168:169], v[204:205]
    v_pk_fma_f32 v[126:127], v[166:167], v[206:207], v[198:199] neg_lo:[1,0,0] neg_hi:[1,0,0]
    v_pk_fma_f32 v[134:135], v[166:167], v[206:207], v[198:199]
    v_pk_mul_f32 v[142:143], v[170:171], v[206:207]
    v_pk_fma_f32 v[128:129], v[164:165], v[208:209], v[200:201] neg_lo:[1,0,0] neg_hi:[1,0,0]
    v_pk_fma_f32 v[136:137], v[164:165], v[208:209], v[200:201]
    v_pk_mul_f32 v[144:145], v[168:169], v[208:209]
    v_pk_fma_f32 v[130:131], v[166:167], v[210:211], v[202:203] neg_lo:[1,0,0] neg_hi:[1,0,0]
    v_pk_fma_f32 v[138:139], v[166:167], v[210:211], v[202:203]
    v_pk_mul_f32 v[146:147], v[170:171], v[210:211]
    s_mov_b32 s57, 1048576
L_lw_49:
    ds_read_b32 v212, v22 offset:48
    s_waitcnt lgkmcnt(0)
    v_cmp_ne_u32 vcc, s56, v212
    s_cbranch_vccz L_lwd_50
    s_sub_u32 s57, s57, 1
    s_cmp_lg_u32 s57, 0
    s_cbranch_scc1 L_lw_49
L_lwd_50:
    ds_read_b128 v[148:151], v28 offset:0
    ds_read_b128 v[152:155], v28 offset:8192
    ds_read_b128 v[156:159], v28 offset:1024
    ds_read_b128 v[160:163], v28 offset:9216
    ds_read_b128 v[164:167], v29 offset:0
    ds_read_b128 v[168:171], v29 offset:8192
    ds_read_b128 v[172:175], v29 offset:1024
    ds_read_b128 v[176:179], v29 offset:9216
    s_lshl_b32 s75, s53, 10
    s_add_u32 m0, s75, 0
    s_add_u32 s76, s87, 0
    buffer_load_dwordx4 v252, s[60:63], s76 offen lds
    s_add_u32 m0, s75, 4096
    s_add_u32 s76, s87, 65536
    buffer_load_dwordx4 v252, s[60:63], s76 offen lds
    s_add_u32 m0, s75, 8192
    s_add_u32 s76, s87, 131072
    buffer_load_dwordx4 v252, s[60:63], s76 offen lds
    s_add_u32 m0, s75, 12288
    s_add_u32 s76, s87, 196608
    buffer_load_dwordx4 v252, s[60:63], s76 offen lds
    s_add_u32 m0, s75, 16384
    s_add_u32 s76, s87, 262144
    buffer_load_dwordx4 v252, s[60:63], s76 offen lds
    s_add_u32 m0, s75, 20480
    s_add_u32 s76, s87, 327680
    buffer_load_dwordx4 v252, s[60:63], s76 offen lds
    s_add_u32 m0, s75, 24576
    s_add_u32 s76, s87, 393216
    buffer_load_dwordx4 v252, s[60:63], s76 offen lds
    s_add_u32 m0, s75, 28672
    s_add_u32 s76, s87, 458752
    buffer_load_dwordx4 v252, s[60:63], s76 offen lds
    s_add_u32 m0, s75, 32768
    s_add_u32 s76, s87, 524288
    buffer_load_dwordx4 v252, s[60:63], s76 offen lds
    s_add_u32 m0, s75, 36864
    s_add_u32 s76, s87, 589824
    buffer_load_dwordx4 v252, s[60:63], s76 offen lds
    s_cmp_lg_u32 s2, 0
    s_cbranch_scc1 L_b2m_48
    ds_read_b128 v[224:227], v27 offset:0
    ds_read_b128 v[228:231], v27 offset:8192
    ds_read_b128 v[232:235], v27 offset:1024
    ds_read_b128 v[236:239], v27 offset:9216
    s_waitcnt lgkmcnt(0)
    s_cmp_lg_u32 s84, 0
    s_cbranch_scc1 L_b2m_48
    v_xor_b32 v166, 2147516416, v166
    v_xor_b32 v167, 2147516416, v167
    v_xor_b32 v170, 2147516416, v170
    v_xor_b32 v171, 2147516416, v171
    v_xor_b32 v174, 2147516416, v174
    v_xor_b32 v175, 2147516416, v175
    v_xor_b32 v178, 2147516416, v178
    v_xor_b32 v179, 2147516416, v179
L_b2m_48:
    s_waitcnt lgkmcnt(0)
    v_mfma_f32_16x16x32_bf16 v[180:183], v[148:151], v[58:61], 0
    v_mfma_f32_16x16x32_bf16 v[184:187], v[148:151], v[56:59], 0
    v_mfma_f32_16x16x32_bf16 v[180:183], v[152:155], v[64:67], v[180:183]
    v_mfma_f32_16x16x32_bf16 v[184:187], v[152:155], v[62:65], v[184:187]
    v_mfma_f32_16x16x32_bf16 v[188:191], v[156:159], v[58:61], 0
    v_mfma_f32_16x16x32_bf16 v[192:195], v[156:159], v[56:59], 0
    v_mfma_f32_16x16x32_bf16 v[188:191], v[160:163], v[64:67], v[188:191]
    v_mfma_f32_16x16x32_bf16 v[192:195], v[160:163], v[62:65], v[192:195]
    v_mfma_f32_16x16x32_bf16 v[196:199], v[164:167], v[58:61], 0
    v_mfma_f32_16x16x32_bf16 v[200:203], v[164:167], v[56:59], 0
    v_mfma_f32_16x16x32_bf16 v[196:199], v[168:171], v[64:67], v[196:199]
    v_mfma_f32_16x16x32_bf16 v[200:203], v[168:171], v[62:65], v[200:203]
    v_mfma_f32_16x16x32_bf16 v[204:207], v[172:175], v[58:61], 0
    v_mfma_f32_16x16x32_bf16 v[208:211], v[172:175], v[56:59], 0
    v_mfma_f32_16x16x32_bf16 v[204:207], v[176:179], v[64:67], v[204:207]
    v_mfma_f32_16x16x32_bf16 v[208:211], v[176:179], v[62:65], v[208:211]
    v_pk_mul_f32 v[212:213], v[180:181], v[68:69]
    v_pk_mul_f32 v[214:215], v[182:183], v[70:71]
    v_pk_mul_f32 v[216:217], v[184:185], v[68:69]
    v_pk_mul_f32 v[218:219], v[186:187], v[70:71]
    v_pk_fma_f32 v[212:213], v[184:185], v[72:73], v[212:213]
    v_pk_fma_f32 v[214:215], v[186:187], v[74:75], v[214:215]
    v_pk_fma_f32 v[216:217], v[180:181], v[72:73], v[216:217] neg_lo:[1,0,0] neg_hi:[1,0,0]
    v_pk_fma_f32 v[218:219], v[182:183], v[74:75], v[218:219] neg_lo:[1,0,0] neg_hi:[1,0,0]
    v_cvt_pk_bf16_f32 v148, v212, v213
    v_cvt_pk_bf16_f32 v149, v214, v215
    v_cvt_pk_bf16_f32 v150, v216, v217
    v_cvt_pk_bf16_f32 v151, v218, v219
    v_pk_mul_f32 v[172:173], v[188:189], v[76:77]
    v_pk_mul_f32 v[174:175], v[190:191], v[78:79]
    v_pk_mul_f32 v[176:177], v[192:193], v[76:77]
    v_pk_mul_f32 v[178:179], v[194:195], v[78:79]
    v_pk_fma_f32 v[172:173], v[192:193], v[80:81], v[172:173]
    v_pk_fma_f32 v[174:175], v[194:195], v[82:83], v[174:175]
    v_pk_fma_f32 v[176:177], v[188:189], v[80:81], v[176:177] neg_lo:[1,0,0] neg_hi:[1,0,0]
    v_pk_fma_f32 v[178:179], v[190:191], v[82:83], v[178:179] neg_lo:[1,0,0] neg_hi:[1,0,0]
    v_cvt_pk_bf16_f32 v152, v172, v173
    v_cvt_pk_bf16_f32 v153, v174, v175
    v_cvt_pk_bf16_f32 v154, v176, v177
    v_cvt_pk_bf16_f32 v155, v178, v179
    v_pk_mul_f32 v[212:213], v[196:197], v[68:69]
    v_pk_mul_f32 v[214:215], v[198:199], v[70:71]
    v_pk_mul_f32 v[216:217], v[200:201], v[68:69]
    v_pk_mul_f32 v[218:219], v[202:203], v[70:71]
    v_pk_fma_f32 v[212:213], v[200:201], v[72:73], v[212:213]
    v_pk_fma_f32 v[214:215], v[202:203], v[74:75], v[214:215]
    v_pk_fma_f32 v[216:217], v[196:197], v[72:73], v[216:217] neg_lo:[1,0,0] neg_hi:[1,0,0]
    v_pk_fma_f32 v[218:219], v[198:199], v[74:75], v[218:219] neg_lo:[1,0,0] neg_hi:[1,0,0]
    v_cvt_pk_bf16_f32 v156, v212, v213
    v_cvt_pk_bf16_f32 v157, v214, v215
    v_cvt_pk_bf16_f32 v158, v216, v217
    v_cvt_pk_bf16_f32 v159, v218, v219
    v_pk_mul_f32 v[172:173], v[204:205], v[76:77]
    v_pk_mul_f32 v[174:175], v[206:207], v[78:79]
    v_pk_mul_f32 v[176:177], v[208:209], v[76:77]
    v_pk_mul_f32 v[178:179], v[210:211], v[78:79]
    v_pk_fma_f32 v[172:173], v[208:209], v[80:81], v[172:173]
    v_pk_fma_f32 v[174:175], v[210:211], v[82:83], v[174:175]
    v_pk_fma_f32 v[176:177], v[204:205], v[80:81], v[176:177] neg_lo:[1,0,0] neg_hi:[1,0,0]
    v_pk_fma_f32 v[178:179], v[206:207], v[82:83], v[178:179] neg_lo:[1,0,0] neg_hi:[1,0,0]
    v_cvt_pk_bf16_f32 v160, v172, v173
    v_cvt_pk_bf16_f32 v161, v174, v175
    v_cvt_pk_bf16_f32 v162, v176, v177
    v_cvt_pk_bf16_f32 v163, v178, v179
    v_mfma_f32_16x16x32_bf16 v[180:183], v[34:37], v[148:151], 0
    v_mfma_f32_16x16x32_bf16 v[184:187], v[32:35], v[148:151], 0
    v_mfma_f32_16x16x32_bf16 v[180:183], v[40:43], v[152:155], v[180:183]
    v_mfma_f32_16x16x32_bf16 v[184:187], v[38:41], v[152:155], v[184:187]
    v_mfma_f32_16x16x32_bf16 v[188:191], v[46:49], v[148:151], 0
    v_mfma_f32_16x16x32_bf16 v[192:195], v[44:47], v[148:151], 0
    v_mfma_f32_16x16x32_bf16 v[188:191], v[52:55], v[152:155], v[188:191]
    v_mfma_f32_16x16x32_bf16 v[192:195], v[50:53], v[152:155], v[192:195]
    v_mfma_f32_16x16x32_bf16 v[196:199], v[34:37], v[156:159], 0
    v_mfma_f32_16x16x32_bf16 v[200:203], v[32:35], v[156:159], 0
    v_mfma_f32_16x16x32_bf16 v[196:199], v[40:43], v[160:163], v[196:199]
    v_mfma_f32_16x16x32_bf16 v[200:203], v[38:41], v[160:163], v[200:203]
    v_mfma_f32_16x16x32_bf16 v[204:207], v[46:49], v[156:159], 0
    v_mfma_f32_16x16x32_bf16 v[208:211], v[44:47], v[156:159], 0
    v_mfma_f32_16x16x32_bf16 v[204:207], v[52:55], v[160:163], v[204:207]
    v_mfma_f32_16x16x32_bf16 v[208:211], v[50:53], v[160:163], v[208:211]
    v_pk_mul_f32 v[164:165], v[100:101], v[180:181]
    v_pk_mul_f32 v[166:167], v[102:103], v[182:183]
    v_pk_mul_f32 v[168:169], v[100:101], v[184:185]
    v_pk_mul_f32 v[170:171], v[102:103], v[186:187]
    v_pk_mul_f32 v[172:173], v[120:121], v[180:181]
    v_pk_mul_f32 v[174:175], v[122:123], v[182:183]
    v_pk_mul_f32 v[176:177], v[120:121], v[184:185]
    v_pk_mul_f32 v[178:179], v[122:123], v[186:187]
    v_pk_fma_f32 v[164:165], v[104:105], v[184:185], v[164:165] neg_lo:[1,0,0] neg_hi:[1,0,0]
    v_pk_fma_f32 v[166:167], v[106:107], v[186:187], v[166:167] neg_lo:[1,0,0] neg_hi:[1,0,0]
    v_pk_fma_f32 v[168:169], v[104:105], v[180:181], v[168:169]
    v_pk_fma_f32 v[170:171], v[106:107], v[182:183], v[170:171]
    v_pk_fma_f32 v[172:173], v[116:117], v[184:185], v[172:173]
    v_pk_fma_f32 v[174:175], v[118:119], v[186:187], v[174:175]
    v_pk_fma_f32 v[176:177], v[116:117], v[180:181], v[176:177] neg_lo:[1,0,0] neg_hi:[1,0,0]
    v_pk_fma_f32 v[178:179], v[118:119], v[182:183], v[178:179] neg_lo:[1,0,0] neg_hi:[1,0,0]
    v_pk_fma_f32 v[164:165], v[120:121], v[196:197], v[164:165] neg_lo:[1,0,0] neg_hi:[1,0,0]
    v_pk_fma_f32 v[166:167], v[122:123], v[198:199], v[166:167] neg_lo:[1,0,0] neg_hi:[1,0,0]
    v_pk_fma_f32 v[168:169], v[120:121], v[200:201], v[168:169] neg_lo:[1,0,0] neg_hi:[1,0,0]
    v_pk_fma_f32 v[170:171], v[122:123], v[202:203], v[170:171] neg_lo:[1,0,0] neg_hi:[1,0,0]
    v_pk_fma_f32 v[172:173], v[108:109], v[196:197], v[172:173]
    v_pk_fma_f32 v[174:175], v[110:111], v[198:199], v[174:175]
    v_pk_fma_f32 v[176:177], v[108:109], v[200:201], v[176:177]
    v_pk_fma_f32 v[178:179], v[110:111], v[202:203], v[178:179]
    v_pk_fma_f32 v[164:165], v[116:117], v[200:201], v[164:165] neg_lo:[1,0,0] neg_hi:[1,0,0]
    v_pk_fma_f32 v[166:167], v[118:119], v[202:203], v[166:167] neg_lo:[1,0,0] neg_hi:[1,0,0]
    v_pk_fma_f32 v[168:169], v[116:117], v[196:197], v[168:169]
    v_pk_fma_f32 v[170:171], v[118:119], v[198:199], v[170:171]
    v_pk_fma_f32 v[172:173], v[112:113], v[200:201], v[172:173] neg_lo:[1,0,0] neg_hi:[1,0,0]
    v_pk_fma_f32 v[174:175], v[114:115], v[202:203], v[174:175] neg_lo:[1,0,0] neg_hi:[1,0,0]
    v_pk_fma_f32 v[176:177], v[112:113], v[196:197], v[176:177]
    v_pk_fma_f32 v[178:179], v[114:115], v[198:199], v[178:179]
    v_cvt_pk_bf16_f32 v148, v168, v169
    v_cvt_pk_bf16_f32 v149, v170, v171
    v_cvt_pk_bf16_f32 v150, v164, v165
    v_cvt_pk_bf16_f32 v151, v166, v167
    v_cvt_pk_bf16_f32 v156, v176, v177
    v_cvt_pk_bf16_f32 v157, v178, v179
    v_cvt_pk_bf16_f32 v158, v172, v173
    v_cvt_pk_bf16_f32 v159, v174, v175
    v_pk_mul_f32 v[164:165], v[124:125], v[188:189]
    v_pk_mul_f32 v[166:167], v[126:127], v[190:191]
    v_pk_mul_f32 v[168:169], v[124:125], v[192:193]
    v_pk_mul_f32 v[170:171], v[126:127], v[194:195]
    v_pk_mul_f32 v[172:173], v[144:145], v[188:189]
    v_pk_mul_f32 v[174:175], v[146:147], v[190:191]
    v_pk_mul_f32 v[176:177], v[144:145], v[192:193]
    v_pk_mul_f32 v[178:179], v[146:147], v[194:195]
    v_pk_fma_f32 v[164:165], v[128:129], v[192:193], v[164:165] neg_lo:[1,0,0] neg_hi:[1,0,0]
    v_pk_fma_f32 v[166:167], v[130:131], v[194:195], v[166:167] neg_lo:[1,0,0] neg_hi:[1,0,0]
    v_pk_fma_f32 v[168:169], v[128:129], v[188:189], v[168:169]
    v_pk_fma_f32 v[170:171], v[130:131], v[190:191], v[170:171]
    v_pk_fma_f32 v[172:173], v[140:141], v[192:193], v[172:173]
    v_pk_fma_f32 v[174:175], v[142:143], v[194:195], v[174:175]
    v_pk_fma_f32 v[176:177], v[140:141], v[188:189], v[176:177] neg_lo:[1,0,0] neg_hi:[1,0,0]
    v_pk_fma_f32 v[178:179], v[142:143], v[190:191], v[178:179] neg_lo:[1,0,0] neg_hi:[1,0,0]
    v_pk_fma_f32 v[164:165], v[144:145], v[204:205], v[164:165] neg_lo:[1,0,0] neg_hi:[1,0,0]
    v_pk_fma_f32 v[166:167], v[146:147], v[206:207], v[166:167] neg_lo:[1,0,0] neg_hi:[1,0,0]
    v_pk_fma_f32 v[168:169], v[144:145], v[208:209], v[168:169] neg_lo:[1,0,0] neg_hi:[1,0,0]
    v_pk_fma_f32 v[170:171], v[146:147], v[210:211], v[170:171] neg_lo:[1,0,0] neg_hi:[1,0,0]
    v_pk_fma_f32 v[172:173], v[132:133], v[204:205], v[172:173]
    v_pk_fma_f32 v[174:175], v[134:135], v[206:207], v[174:175]
    v_pk_fma_f32 v[176:177], v[132:133], v[208:209], v[176:177]
    v_pk_fma_f32 v[178:179], v[134:135], v[210:211], v[178:179]
    v_pk_fma_f32 v[164:165], v[140:141], v[208:209], v[164:165] neg_lo:[1,0,0] neg_hi:[1,0,0]
    v_pk_fma_f32 v[166:167], v[142:143], v[210:211], v[166:167] neg_lo:[1,0,0] neg_hi:[1,0,0]
    v_pk_fma_f32 v[168:169], v[140:141], v[204:205], v[168:169]
    v_pk_fma_f32 v[170:171], v[142:143], v[206:207], v[170:171]
    v_pk_fma_f32 v[172:173], v[136:137], v[208:209], v[172:173] neg_lo:[1,0,0] neg_hi:[1,0,0]
    v_pk_fma_f32 v[174:175], v[138:139], v[210:211], v[174:175] neg_lo:[1,0,0] neg_hi:[1,0,0]
    v_pk_fma_f32 v[176:177], v[136:137], v[204:205], v[176:177]
    v_pk_fma_f32 v[178:179], v[138:139], v[206:207], v[178:179]
    v_cvt_pk_bf16_f32 v152, v168, v169
    v_cvt_pk_bf16_f32 v153, v170, v171
    v_cvt_pk_bf16_f32 v154, v164, v165
    v_cvt_pk_bf16_f32 v155, v166, v167
    v_cvt_pk_bf16_f32 v160, v176, v177
    v_cvt_pk_bf16_f32 v161, v178, v179
    v_cvt_pk_bf16_f32 v162, v172, v173
    v_cvt_pk_bf16_f32 v163, v174, v175
    v_mfma_f32_16x16x32_bf16 v[180:183], v[148:151], v[32:35], 0
    v_mfma_f32_16x16x32_bf16 v[184:187], v[148:151], v[34:37], 0
    v_mfma_f32_16x16x32_bf16 v[180:183], v[152:155], v[38:41], v[180:183]
    v_mfma_f32_16x16x32_bf16 v[184:187], v[152:155], v[40:43], v[184:187]
    v_mfma_f32_16x16x32_bf16 v[188:191], v[148:151], v[44:47], 0
    v_mfma_f32_16x16x32_bf16 v[192:195], v[148:151], v[46:49], 0
    v_mfma_f32_16x16x32_bf16 v[188:191], v[152:155], v[50:53], v[188:191]
    v_mfma_f32_16x16x32_bf16 v[192:195], v[152:155], v[52:55], v[192:195]
    v_mfma_f32_16x16x32_bf16 v[196:199], v[156:159], v[32:35], 0
    v_mfma_f32_16x16x32_bf16 v[200:203], v[156:159], v[34:37], 0
    v_mfma_f32_16x16x32_bf16 v[196:199], v[160:163], v[38:41], v[196:199]
    v_mfma_f32_16x16x32_bf16 v[200:203], v[160:163], v[40:43], v[200:203]
    v_mfma_f32_16x16x32_bf16 v[204:207], v[156:159], v[44:47], 0
    v_mfma_f32_16x16x32_bf16 v[208:211], v[156:159], v[46:49], 0
    v_mfma_f32_16x16x32_bf16 v[204:207], v[160:163], v[50:53], v[204:207]
    v_mfma_f32_16x16x32_bf16 v[208:211], v[160:163], v[52:55], v[208:211]
    s_lshl_b32 s75, s73, 12
    s_lshl_b32 s76, s72, 11
    s_add_u32 s75, s75, s76
    s_add_u32 s75, s75, 147456
    v_lshlrev_b32 v24, 4, v0
    v_add_u32 v24, s75, v24
    v_xor_b32 v25, 2048, v24
    v_pk_mul_f32 v[212:213], v[180:181], v[84:85]
    v_pk_mul_f32 v[214:215], v[182:183], v[86:87]
    v_pk_mul_f32 v[216:217], v[184:185], v[84:85]
    v_pk_mul_f32 v[218:219], v[186:187], v[86:87]
    v_pk_fma_f32 v[212:213], v[184:185], v[88:89], v[212:213] neg_lo:[1,0,0] neg_hi:[1,0,0]
    v_pk_fma_f32 v[214:215], v[186:187], v[90:91], v[214:215] neg_lo:[1,0,0] neg_hi:[1,0,0]
    v_pk_fma_f32 v[216:217], v[180:181], v[88:89], v[216:217]
    v_pk_fma_f32 v[218:219], v[182:183], v[90:91], v[218:219]
    v_cvt_pk_bf16_f32 v164, v216, v217
    v_cvt_pk_bf16_f32 v165, v218, v219
    v_cvt_pk_bf16_f32 v166, v212, v213
    v_cvt_pk_bf16_f32 v167, v214, v215
    v_pk_mul_f32 v[148:149], v[188:189], v[92:93]
    v_pk_mul_f32 v[150:151], v[190:191], v[94:95]
    v_pk_mul_f32 v[152:153], v[192:193], v[92:93]
    v_pk_mul_f32 v[154:155], v[194:195], v[94:95]
    v_pk_fma_f32 v[148:149], v[192:193], v[96:97], v[148:149] neg_lo:[1,0,0] neg_hi:[1,0,0]
    v_pk_fma_f32 v[150:151], v[194:195], v[98:99], v[150:151] neg_lo:[1,0,0] neg_hi:[1,0,0]
    v_pk_fma_f32 v[152:153], v[188:189], v[96:97], v[152:153]
    v_pk_fma_f32 v[154:155], v[190:191], v[98:99], v[154:155]
    v_cvt_pk_bf16_f32 v168, v152, v153
    v_cvt_pk_bf16_f32 v169, v154, v155
    v_cvt_pk_bf16_f32 v170, v148, v149
    v_cvt_pk_bf16_f32 v171, v150, v151
    v_pk_mul_f32 v[212:213], v[196:197], v[84:85]
    v_pk_mul_f32 v[214:215], v[198:199], v[86:87]
    v_pk_mul_f32 v[216:217], v[200:201], v[84:85]
    v_pk_mul_f32 v[218:219], v[202:203], v[86:87]
    v_pk_fma_f32 v[212:213], v[200:201], v[88:89], v[212:213] neg_lo:[1,0,0] neg_hi:[1,0,0]
    v_pk_fma_f32 v[214:215], v[202:203], v[90:91], v[214:215] neg_lo:[1,0,0] neg_hi:[1,0,0]
    v_pk_fma_f32 v[216:217], v[196:197], v[88:89], v[216:217]
    v_pk_fma_f32 v[218:219], v[198:199], v[90:91], v[218:219]
    v_cvt_pk_bf16_f32 v172, v216, v217
    v_cvt_pk_bf16_f32 v173, v218, v219
    v_cvt_pk_bf16_f32 v174, v212, v213
    v_cvt_pk_bf16_f32 v175, v214, v215
    v_pk_mul_f32 v[148:149], v[204:205], v[92:93]
    v_pk_mul_f32 v[150:151], v[206:207], v[94:95]
    v_pk_mul_f32 v[152:153], v[208:209], v[92:93]
    v_pk_mul_f32 v[154:155], v[210:211], v[94:95]
    v_pk_fma_f32 v[148:149], v[208:209], v[96:97], v[148:149] neg_lo:[1,0,0] neg_hi:[1,0,0]
    v_pk_fma_f32 v[150:151], v[210:211], v[98:99], v[150:151] neg_lo:[1,0,0] neg_hi:[1,0,0]
    v_pk_fma_f32 v[152:153], v[204:205], v[96:97], v[152:153]
    v_pk_fma_f32 v[154:155], v[206:207], v[98:99], v[154:155]
    v_cvt_pk_bf16_f32 v176, v152, v153
    v_cvt_pk_bf16_f32 v177, v154, v155
    v_cvt_pk_bf16_f32 v178, v148, v149
    v_cvt_pk_bf16_f32 v179, v150, v151
    s_cmp_eq_u32 s72, 0
    s_cselect_b64 vcc, -1, 0
    v_cndmask_b32 v148, v164, v172, vcc
    v_cndmask_b32 v149, v165, v173, vcc
    v_cndmask_b32 v150, v166, v174, vcc
    v_cndmask_b32 v151, v167, v175, vcc
    v_cndmask_b32 v152, v168, v176, vcc
    v_cndmask_b32 v153, v169, v177, vcc
    v_cndmask_b32 v154, v170, v178, vcc
    v_cndmask_b32 v155, v171, v179, vcc
    v_cndmask_b32 v156, v172, v164, vcc
    v_cndmask_b32 v157, v173, v165, vcc
    v_cndmask_b32 v158, v174, v166, vcc
    v_cndmask_b32 v159, v175, v167, vcc
    v_cndmask_b32 v160, v176, v168, vcc
    v_cndmask_b32 v161, v177, v169, vcc
    v_cndmask_b32 v162, v178, v170, vcc
    v_cndmask_b32 v163, v179, v171, vcc
    ds_write_b128 v24, v[148:151] offset:0
    ds_write_b128 v24, v[152:155] offset:1024
    s_mov_b64 exec, 1
    ds_write_b32 v23, v20 offset:64
    s_mov_b64 exec, -1
    s_mov_b32 s57, 1048576
L_lw_51:
    ds_read_b32 v212, v22 offset:64
    s_waitcnt lgkmcnt(0)
    v_cmp_ne_u32 vcc, s56, v212
    s_cbranch_vccz L_lwd_52
    s_sub_u32 s57, s57, 1
    s_cmp_lg_u32 s57, 0
    s_cbranch_scc1 L_lw_51
L_lwd_52:
    ds_read_b128 v[164:167], v25 offset:0
    ds_read_b128 v[168:171], v25 offset:1024
    s_cmp_lg_u32 s72, 0
    s_cbranch_scc1 L_c1_53
    v_mfma_f32_16x16x32_bf16 v[180:183], v[32:35], v[156:159], 0
    v_mfma_f32_16x16x32_bf16 v[184:187], v[34:37], v[156:159], 0
    v_mfma_f32_16x16x32_bf16 v[188:191], v[32:35], v[160:163], 0
    v_mfma_f32_16x16x32_bf16 v[192:195], v[34:37], v[160:163], 0
    v_mfma_f32_16x16x32_bf16 v[196:199], v[44:47], v[156:159], 0
    v_mfma_f32_16x16x32_bf16 v[200:203], v[46:49], v[156:159], 0
    v_mfma_f32_16x16x32_bf16 v[204:207], v[44:47], v[160:163], 0
    v_mfma_f32_16x16x32_bf16 v[208:211], v[46:49], v[160:163], 0
    s_waitcnt lgkmcnt(0)
    v_mfma_f32_16x16x32_bf16 v[180:183], v[38:41], v[164:167], v[180:183]
    v_mfma_f32_16x16x32_bf16 v[184:187], v[40:43], v[164:167], v[184:187]
    v_mfma_f32_16x16x32_bf16 v[188:191], v[38:41], v[168:171], v[188:191]
    v_mfma_f32_16x16x32_bf16 v[192:195], v[40:43], v[168:171], v[192:195]
    v_mfma_f32_16x16x32_bf16 v[196:199], v[50:53], v[164:167], v[196:199]
    v_mfma_f32_16x16x32_bf16 v[200:203], v[52:55], v[164:167], v[200:203]
    v_mfma_f32_16x16x32_bf16 v[204:207], v[50:53], v[168:171], v[204:207]
    v_mfma_f32_16x16x32_bf16 v[208:211], v[52:55], v[168:171], v[208:211]
    s_branch L_c2_54
L_c1_53:
    v_mfma_f32_16x16x32_bf16 v[180:183], v[38:41], v[156:159], 0
    v_mfma_f32_16x16x32_bf16 v[184:187], v[40:43], v[156:159], 0
    v_mfma_f32_16x16x32_bf16 v[188:191], v[38:41], v[160:163], 0
    v_mfma_f32_16x16x32_bf16 v[192:195], v[40:43], v[160:163], 0
    v_mfma_f32_16x16x32_bf16 v[196:199], v[50:53], v[156:159], 0
    v_mfma_f32_16x16x32_bf16 v[200:203], v[52:55], v[156:159], 0
    v_mfma_f32_16x16x32_bf16 v[204:207], v[50:53], v[160:163], 0
    v_mfma_f32_16x16x32_bf16 v[208:211], v[52:55], v[160:163], 0
    s_waitcnt lgkmcnt(0)
    v_mfma_f32_16x16x32_bf16 v[180:183], v[32:35], v[164:167], v[180:183]
    v_mfma_f32_16x16x32_bf16 v[184:187], v[34:37], v[164:167], v[184:187]
    v_mfma_f32_16x16x32_bf16 v[188:191], v[32:35], v[168:171], v[188:191]
    v_mfma_f32_16x16x32_bf16 v[192:195], v[34:37], v[168:171], v[192:195]
    v_mfma_f32_16x16x32_bf16 v[196:199], v[44:47], v[164:167], v[196:199]
    v_mfma_f32_16x16x32_bf16 v[200:203], v[46:49], v[164:167], v[200:203]
    v_mfma_f32_16x16x32_bf16 v[204:207], v[44:47], v[168:171], v[204:207]
    v_mfma_f32_16x16x32_bf16 v[208:211], v[46:49], v[168:171], v[208:211]
L_c2_54:
    s_cmp_eq_u32 s72, 0
    s_cselect_b32 s74, 0, 2147516416
    s_lshl_b32 s75, s72, 1
    s_add_u32 s75, s75, s73
    s_cmp_lg_u32 s79, 0
    s_cselect_b32 s75, 2, s75
    v_and_b32 v26, 15, v0
    v_lshrrev_b32 v27, 2, v26
    v_xor_b32 v27, s75, v27
    v_lshlrev_b32 v27, 4, v27
    v_lshl_add_u32 v27, v26, 6, v27
    v_lshrrev_b32 v26, 4, v0
    v_lshl_add_u32 v27, v26, 11, v27
    v_add_u32 v27, 131072, v27
    v_cvt_pk_bf16_f32 v148, v180, v181
    v_cvt_pk_bf16_f32 v149, v182, v183
    v_cvt_pk_bf16_f32 v150, v184, v185
    v_cvt_pk_bf16_f32 v151, v186, v187
    v_xor_b32 v150, s74, v150
    v_xor_b32 v151, s74, v151
    v_cvt_pk_bf16_f32 v152, v188, v189
    v_cvt_pk_bf16_f32 v153, v190, v191
    v_cvt_pk_bf16_f32 v154, v192, v193
    v_cvt_pk_bf16_f32 v155, v194, v195
    v_xor_b32 v154, s74, v154
    v_xor_b32 v155, s74, v155
    v_cvt_pk_bf16_f32 v156, v196, v197
    v_cvt_pk_bf16_f32 v157, v198, v199
    v_cvt_pk_bf16_f32 v158, v200, v201
    v_cvt_pk_bf16_f32 v159, v202, v203
    v_xor_b32 v158, s74, v158
    v_xor_b32 v159, s74, v159
    v_cvt_pk_bf16_f32 v160, v204, v205
    v_cvt_pk_bf16_f32 v161, v206, v207
    v_cvt_pk_bf16_f32 v162, v208, v209
    v_cvt_pk_bf16_f32 v163, v210, v211
    v_xor_b32 v162, s74, v162
    v_xor_b32 v163, s74, v163
    s_cmp_eq_u32 s2, 0
    s_cbranch_scc1 L_w0_55
    ds_write_b128 v27, v[148:151] offset:0
    ds_write_b128 v27, v[152:155] offset:1024
    ds_write_b128 v27, v[156:159] offset:8192
    ds_write_b128 v27, v[160:163] offset:9216
    s_branch L_so_56
L_w0_55:
    s_mov_b64 exec, 1
    ds_write_b32 v23, v20 offset:80
    s_mov_b64 exec, -1
    s_mov_b32 s57, 1048576
L_lw_57:
    ds_read_b32 v212, v22 offset:80
    s_waitcnt lgkmcnt(0)
    v_cmp_ne_u32 vcc, s56, v212
    s_cbranch_vccz L_lwd_58
    s_sub_u32 s57, s57, 1
    s_cmp_lg_u32 s57, 0
    s_cbranch_scc1 L_lw_57
L_lwd_58:
    s_cmp_eq_u32 s84, 0
    s_cbranch_scc1 L_s1_59
    ds_write_b128 v27, v[148:151] offset:0
    ds_write_b128 v27, v[152:155] offset:1024
    ds_write_b128 v27, v[156:159] offset:8192
    ds_write_b128 v27, v[160:163] offset:9216
    s_branch L_s2_60
L_s1_59:
    s_cmp_eq_u32 s72, 0
    s_cbranch_scc1 L_s2_60
    v_lshlrev_b32 v24, 4, v0
    v_add_u32 v24, 147456, v24
    ds_write_b128 v24, v[148:151] offset:0
    ds_write_b128 v24, v[152:155] offset:1024
    ds_write_b128 v24, v[156:159] offset:2048
    ds_write_b128 v24, v[160:163] offset:3072
L_s2_60:
    s_mov_b64 exec, 1
    ds_write_b32 v23, v20 offset:96
    s_mov_b64 exec, -1
    s_mov_b32 s57, 1048576
L_lw_62:
    ds_read_b32 v212, v22 offset:96
    s_waitcnt lgkmcnt(0)
    v_cmp_ne_u32 vcc, s56, v212
    s_cbranch_vccz L_lwd_63
    s_sub_u32 s57, s57, 1
    s_cmp_lg_u32 s57, 0
    s_cbranch_scc1 L_lw_62
L_lwd_63:
    s_or_b32 s75, s84, s72
    s_cmp_lg_u32 s75, 0
    s_cbranch_scc1 L_so_56
    v_lshlrev_b32 v24, 4, v0
    v_add_u32 v24, 147456, v24
    ds_read_b128 v[164:167], v24 offset:0
    ds_read_b128 v[168:171], v24 offset:1024
    ds_read_b128 v[172:175], v24 offset:2048
    ds_read_b128 v[176:179], v24 offset:3072
    s_mov_b32 s75, 0xffff0000
    s_waitcnt lgkmcnt(0)
    v_lshlrev_b32 v180, 16, v148
    v_and_b32 v181, s75, v148
    v_lshlrev_b32 v182, 16, v164
    v_and_b32 v183, s75, v164
    v_add_f32 v180, v180, v182
    v_add_f32 v181, v181, v183
    v_mul_f32 v180, 0.5, v180
    v_mul_f32 v181, 0.5, v181
    v_cvt_pk_bf16_f32 v148, v180, v181
    v_lshlrev_b32 v180, 16, v149
    v_and_b32 v181, s75, v149
    v_lshlrev_b32 v182, 16, v165
    v_and_b32 v183, s75, v165
    v_add_f32 v180, v180, v182
    v_add_f32 v181, v181, v183
    v_mul_f32 v180, 0.5, v180
    v_mul_f32 v181, 0.5, v181
    v_cvt_pk_bf16_f32 v149, v180, v181
    v_lshlrev_b32 v180, 16, v150
    v_and_b32 v181, s75, v150
    v_lshlrev_b32 v182, 16, v166
    v_and_b32 v183, s75, v166
    v_add_f32 v180, v180, v182
    v_add_f32 v181, v181, v183
    v_mul_f32 v180, 0.5, v180
    v_mul_f32 v181, 0.5, v181
    v_cvt_pk_bf16_f32 v150, v180, v181
    v_lshlrev_b32 v180, 16, v151
    v_and_b32 v181, s75, v151
    v_lshlrev_b32 v182, 16, v167
    v_and_b32 v183, s75, v167
    v_add_f32 v180, v180, v182
    v_add_f32 v181, v181, v183
    v_mul_f32 v180, 0.5, v180
    v_mul_f32 v181, 0.5, v181
    v_cvt_pk_bf16_f32 v151, v180, v181
    v_lshlrev_b32 v180, 16, v152
    v_and_b32 v181, s75, v152
    v_lshlrev_b32 v182, 16, v168
    v_and_b32 v183, s75, v168
    v_add_f32 v180, v180, v182
    v_add_f32 v181, v181, v183
    v_mul_f32 v180, 0.5, v180
    v_mul_f32 v181, 0.5, v181
    v_cvt_pk_bf16_f32 v152, v180, v181
    v_lshlrev_b32 v180, 16, v153
    v_and_b32 v181, s75, v153
    v_lshlrev_b32 v182, 16, v169
    v_and_b32 v183, s75, v169
    v_add_f32 v180, v180, v182
    v_add_f32 v181, v181, v183
    v_mul_f32 v180, 0.5, v180
    v_mul_f32 v181, 0.5, v181
    v_cvt_pk_bf16_f32 v153, v180, v181
    v_lshlrev_b32 v180, 16, v154
    v_and_b32 v181, s75, v154
    v_lshlrev_b32 v182, 16, v170
    v_and_b32 v183, s75, v170
    v_add_f32 v180, v180, v182
    v_add_f32 v181, v181, v183
    v_mul_f32 v180, 0.5, v180
    v_mul_f32 v181, 0.5, v181
    v_cvt_pk_bf16_f32 v154, v180, v181
    v_lshlrev_b32 v180, 16, v155
    v_and_b32 v181, s75, v155
    v_lshlrev_b32 v182, 16, v171
    v_and_b32 v183, s75, v171
    v_add_f32 v180, v180, v182
    v_add_f32 v181, v181, v183
    v_mul_f32 v180, 0.5, v180
    v_mul_f32 v181, 0.5, v181
    v_cvt_pk_bf16_f32 v155, v180, v181
    v_lshlrev_b32 v180, 16, v156
    v_and_b32 v181, s75, v156
    v_lshlrev_b32 v182, 16, v172
    v_and_b32 v183, s75, v172
    v_add_f32 v180, v180, v182
    v_add_f32 v181, v181, v183
    v_mul_f32 v180, 0.5, v180
    v_mul_f32 v181, 0.5, v181
    v_cvt_pk_bf16_f32 v156, v180, v181
    v_lshlrev_b32 v180, 16, v157
    v_and_b32 v181, s75, v157
    v_lshlrev_b32 v182, 16, v173
    v_and_b32 v183, s75, v173
    v_add_f32 v180, v180, v182
    v_add_f32 v181, v181, v183
    v_mul_f32 v180, 0.5, v180
    v_mul_f32 v181, 0.5, v181
    v_cvt_pk_bf16_f32 v157, v180, v181
    v_lshlrev_b32 v180, 16, v158
    v_and_b32 v181, s75, v158
    v_lshlrev_b32 v182, 16, v174
    v_and_b32 v183, s75, v174
    v_add_f32 v180, v180, v182
    v_add_f32 v181, v181, v183
    v_mul_f32 v180, 0.5, v180
    v_mul_f32 v181, 0.5, v181
    v_cvt_pk_bf16_f32 v158, v180, v181
    v_lshlrev_b32 v180, 16, v159
    v_and_b32 v181, s75, v159
    v_lshlrev_b32 v182, 16, v175
    v_and_b32 v183, s75, v175
    v_add_f32 v180, v180, v182
    v_add_f32 v181, v181, v183
    v_mul_f32 v180, 0.5, v180
    v_mul_f32 v181, 0.5, v181
    v_cvt_pk_bf16_f32 v159, v180, v181
    v_lshlrev_b32 v180, 16, v160
    v_and_b32 v181, s75, v160
    v_lshlrev_b32 v182, 16, v176
    v_and_b32 v183, s75, v176
    v_add_f32 v180, v180, v182
    v_add_f32 v181, v181, v183
    v_mul_f32 v180, 0.5, v180
    v_mul_f32 v181, 0.5, v181
    v_cvt_pk_bf16_f32 v160, v180, v181
    v_lshlrev_b32 v180, 16, v161
    v_and_b32 v181, s75, v161
    v_lshlrev_b32 v182, 16, v177
    v_and_b32 v183, s75, v177
    v_add_f32 v180, v180, v182
    v_add_f32 v181, v181, v183
    v_mul_f32 v180, 0.5, v180
    v_mul_f32 v181, 0.5, v181
    v_cvt_pk_bf16_f32 v161, v180, v181
    v_lshlrev_b32 v180, 16, v162
    v_and_b32 v181, s75, v162
    v_lshlrev_b32 v182, 16, v178
    v_and_b32 v183, s75, v178
    v_add_f32 v180, v180, v182
    v_add_f32 v181, v181, v183
    v_mul_f32 v180, 0.5, v180
    v_mul_f32 v181, 0.5, v181
    v_cvt_pk_bf16_f32 v162, v180, v181
    v_lshlrev_b32 v180, 16, v163
    v_and_b32 v181, s75, v163
    v_lshlrev_b32 v182, 16, v179
    v_and_b32 v183, s75, v179
    v_add_f32 v180, v180, v182
    v_add_f32 v181, v181, v183
    v_mul_f32 v180, 0.5, v180
    v_mul_f32 v181, 0.5, v181
    v_cvt_pk_bf16_f32 v163, v180, v181
    ds_write_b128 v27, v[148:151] offset:0
    ds_write_b128 v27, v[152:155] offset:1024
    ds_write_b128 v27, v[156:159] offset:8192
    ds_write_b128 v27, v[160:163] offset:9216
L_so_56:
    s_mov_b64 exec, 1
    ds_write_b32 v23, v20 offset:112
    s_mov_b64 exec, -1
    s_mov_b32 s57, 1048576
L_lw_64:
    ds_read_b32 v212, v22 offset:112
    s_waitcnt lgkmcnt(0)
    v_cmp_ne_u32 vcc, s56, v212
    s_cbranch_vccz L_lwd_65
    s_sub_u32 s57, s57, 1
    s_cmp_lg_u32 s57, 0
    s_cbranch_scc1 L_lw_64
L_lwd_65:
    s_waitcnt vmcnt(0)
    s_lshl_b32 s75, s53, 2
    s_add_u32 s75, s75, 160288
    v_mov_b32 v212, s75
    s_mov_b64 exec, 1
    ds_write_b32 v212, v20
    s_mov_b64 exec, -1
    s_cmp_lg_u32 s2, 0
    s_cbranch_scc1 L_b2o_47
    s_cmp_lg_u32 s79, 0
    s_cbranch_scc1 L_b2o_47
    s_mov_b32 s79, 1
    s_mov_b32 s73, 0
    s_mov_b32 s84, 0
    v_add_u32 v23, 64, v23
    v_add_u32 v22, 64, v22
    v_mov_b32 v180, v4
    v_mov_b32 v181, v5
    v_mov_b32 v182, v6
    v_mov_b32 v183, v7
    v_mov_b32 v184, v8
    v_mov_b32 v185, v9
    v_mov_b32 v186, v10
    v_mov_b32 v187, v11
    v_mov_b32 v188, v12
    v_mov_b32 v189, v13
    v_mov_b32 v190, v14
    v_mov_b32 v191, v15
    v_mov_b32 v192, v16
    v_mov_b32 v193, v17
    v_mov_b32 v194, v18
    v_mov_b32 v195, v19
    s_lshl_b32 s75, s72, 4
    v_cvt_f32_u32 v176, s75
    v_add_f32 v176, v176, v248
    v_mul_f32 v176, 0x3a000000, v176
    s_mov_b32 s76, 0x3c800000
    s_mov_b32 s77, 0xffff0000
    v_fma_f32 v172, v240, s76, v176
    v_fma_f32 v173, v241, s76, v176
    v_fma_f32 v174, v242, s76, v176
    v_fma_f32 v175, v243, s76, v176
    v_sin_f32 v164, v172
    v_sin_f32 v165, v173
    v_sin_f32 v166, v174
    v_sin_f32 v167, v175
    v_cos_f32 v168, v172
    v_cos_f32 v169, v173
    v_cos_f32 v170, v174
    v_cos_f32 v171, v175
    v_lshlrev_b32 v148, 16, v180
    v_and_b32 v149, s77, v180
    v_lshlrev_b32 v150, 16, v181
    v_and_b32 v151, s77, v181
    v_lshlrev_b32 v152, 16, v182
    v_and_b32 v153, s77, v182
    v_lshlrev_b32 v154, 16, v183
    v_and_b32 v155, s77, v183
    v_lshlrev_b32 v156, 16, v184
    v_and_b32 v157, s77, v184
    v_lshlrev_b32 v158, 16, v185
    v_and_b32 v159, s77, v185
    v_lshlrev_b32 v160, 16, v186
    v_and_b32 v161, s77, v186
    v_lshlrev_b32 v162, 16, v187
    v_and_b32 v163, s77, v187
    v_pk_add_f32 v[196:197], v[148:149], v[156:157]
    v_pk_add_f32 v[198:199], v[150:151], v[158:159]
    v_pk_add_f32 v[200:201], v[152:153], v[160:161]
    v_pk_add_f32 v[202:203], v[154:155], v[162:163]
    v_pk_add_f32 v[204:205], v[148:149], v[156:157] neg_lo:[0,1] neg_hi:[0,1]
    v_pk_add_f32 v[206:207], v[150:151], v[158:159] neg_lo:[0,1] neg_hi:[0,1]
    v_pk_add_f32 v[208:209], v[152:153], v[160:161] neg_lo:[0,1] neg_hi:[0,1]
    v_pk_add_f32 v[210:211], v[154:155], v[162:163] neg_lo:[0,1] neg_hi:[0,1]
    v_pk_fma_f32 v[100:101], v[164:165], v[204:205], v[196:197] neg_lo:[1,0,0] neg_hi:[1,0,0]
    v_pk_fma_f32 v[108:109], v[164:165], v[204:205], v[196:197]
    v_pk_mul_f32 v[116:117], v[168:169], v[204:205]
    v_pk_fma_f32 v[102:103], v[166:167], v[206:207], v[198:199] neg_lo:[1,0,0] neg_hi:[1,0,0]
    v_pk_fma_f32 v[110:111], v[166:167], v[206:207], v[198:199]
    v_pk_mul_f32 v[118:119], v[170:171], v[206:207]
    v_pk_fma_f32 v[104:105], v[164:165], v[208:209], v[200:201] neg_lo:[1,0,0] neg_hi:[1,0,0]
    v_pk_fma_f32 v[112:113], v[164:165], v[208:209], v[200:201]
    v_pk_mul_f32 v[120:121], v[168:169], v[208:209]
    v_pk_fma_f32 v[106:107], v[166:167], v[210:211], v[202:203] neg_lo:[1,0,0] neg_hi:[1,0,0]
    v_pk_fma_f32 v[114:115], v[166:167], v[210:211], v[202:203]
    v_pk_mul_f32 v[122:123], v[170:171], v[210:211]
    v_fma_f32 v172, v244, s76, v176
    v_fma_f32 v173, v245, s76, v176
    v_fma_f32 v174, v246, s76, v176
    v_fma_f32 v175, v247, s76, v176
    v_sin_f32 v164, v172
    v_sin_f32 v165, v173
    v_sin_f32 v166, v174
    v_sin_f32 v167, v175
    v_cos_f32 v168, v172
    v_cos_f32 v169, v173
    v_cos_f32 v170, v174
    v_cos_f32 v171, v175
    v_lshlrev_b32 v148, 16, v188
    v_and_b32 v149, s77, v188
    v_lshlrev_b32 v150, 16, v189
    v_and_b32 v151, s77, v189
    v_lshlrev_b32 v152, 16, v190
    v_and_b32 v153, s77, v190
    v_lshlrev_b32 v154, 16, v191
    v_and_b32 v155, s77, v191
    v_lshlrev_b32 v156, 16, v192
    v_and_b32 v157, s77, v192
    v_lshlrev_b32 v158, 16, v193
    v_and_b32 v159, s77, v193
    v_lshlrev_b32 v160, 16, v194
    v_and_b32 v161, s77, v194
    v_lshlrev_b32 v162, 16, v195
    v_and_b32 v163, s77, v195
    v_pk_add_f32 v[196:197], v[148:149], v[156:157]
    v_pk_add_f32 v[198:199], v[150:151], v[158:159]
    v_pk_add_f32 v[200:201], v[152:153], v[160:161]
    v_pk_add_f32 v[202:203], v[154:155], v[162:163]
    v_pk_add_f32 v[204:205], v[148:149], v[156:157] neg_lo:[0,1] neg_hi:[0,1]
    v_pk_add_f32 v[206:207], v[150:151], v[158:159] neg_lo:[0,1] neg_hi:[0,1]
    v_pk_add_f32 v[208:209], v[152:153], v[160:161] neg_lo:[0,1] neg_hi:[0,1]
    v_pk_add_f32 v[210:211], v[154:155], v[162:163] neg_lo:[0,1] neg_hi:[0,1]
    v_pk_fma_f32 v[124:125], v[164:165], v[204:205], v[196:197] neg_lo:[1,0,0] neg_hi:[1,0,0]
    v_pk_fma_f32 v[132:133], v[164:165], v[204:205], v[196:197]
    v_pk_mul_f32 v[140:141], v[168:169], v[204:205]
    v_pk_fma_f32 v[126:127], v[166:167], v[206:207], v[198:199] neg_lo:[1,0,0] neg_hi:[1,0,0]
    v_pk_fma_f32 v[134:135], v[166:167], v[206:207], v[198:199]
    v_pk_mul_f32 v[142:143], v[170:171], v[206:207]
    v_pk_fma_f32 v[128:129], v[164:165], v[208:209], v[200:201] neg_lo:[1,0,0] neg_hi:[1,0,0]
    v_pk_fma_f32 v[136:137], v[164:165], v[208:209], v[200:201]
    v_pk_mul_f32 v[144:145], v[168:169], v[208:209]
    v_pk_fma_f32 v[130:131], v[166:167], v[210:211], v[202:203] neg_lo:[1,0,0] neg_hi:[1,0,0]
    v_pk_fma_f32 v[138:139], v[166:167], v[210:211], v[202:203]
    v_pk_mul_f32 v[146:147], v[170:171], v[210:211]
    v_mov_b32 v148, v224
    v_mov_b32 v149, v225
    v_xor_b32 v150, 2147516416, v226
    v_xor_b32 v151, 2147516416, v227
    v_mov_b32 v164, v224
    v_mov_b32 v165, v225
    v_mov_b32 v166, v226
    v_mov_b32 v167, v227
    v_mov_b32 v152, v228
    v_mov_b32 v153, v229
    v_xor_b32 v154, 2147516416, v230
    v_xor_b32 v155, 2147516416, v231
    v_mov_b32 v168, v228
    v_mov_b32 v169, v229
    v_mov_b32 v170, v230
    v_mov_b32 v171, v231
    v_mov_b32 v156, v232
    v_mov_b32 v157, v233
    v_xor_b32 v158, 2147516416, v234
    v_xor_b32 v159, 2147516416, v235
    v_mov_b32 v172, v232
    v_mov_b32 v173, v233
    v_mov_b32 v174, v234
    v_mov_b32 v175, v235
    v_mov_b32 v160, v236
    v_mov_b32 v161, v237
    v_xor_b32 v162, 2147516416, v238
    v_xor_b32 v163, 2147516416, v239
    v_mov_b32 v176, v236
    v_mov_b32 v177, v237
    v_mov_b32 v178, v238
    v_mov_b32 v179, v239
    s_branch L_b2m_48
L_b2o_47:
    v_mov_b32 v20, s56
    v_mov_b32 v21, 0
    v_and_b32 v22, 3, v0
    v_lshlrev_b32 v22, 2, v22
    v_add_u32 v22, 160304, v22
    s_lshl_b32 s75, s53, 2
    s_add_u32 s75, s75, 160304
    v_mov_b32 v23, s75
    s_lshl_b32 s75, s53, 6
    v_add_u32 v25, s75, v0
    v_lshrrev_b32 v24, 4, v25
    v_xor_b32 v24, v24, v25
    v_and_b32 v24, 3, v24
    v_lshlrev_b32 v24, 4, v24
    v_and_b32 v29, 0xfc, v25
    v_lshl_add_u32 v24, v29, 4, v24
    v_and_b32 v29, 3, v25
    v_lshrrev_b32 v25, 2, v25
    v_mul_u32_u24 v25, 16512, v25
    v_lshl_add_u32 v25, v29, 4, v25
    v_add_u32 v24, 131072, v24
    ds_read_b128 v[148:151], v24 offset:0
    ds_read_b128 v[152:155], v24 offset:4096
    ds_read_b128 v[156:159], v24 offset:8192
    ds_read_b128 v[160:163], v24 offset:12288
    s_lshl_b32 s75, s2, 6
    s_add_u32 s75, s75, 25165824
    s_waitcnt lgkmcnt(3)
    buffer_store_dwordx4 v[148:151], v25, s[32:35], s75 offen sc1
    s_add_u32 s75, s75, 1056768
    s_waitcnt lgkmcnt(2)
    buffer_store_dwordx4 v[152:155], v25, s[32:35], s75 offen sc1
    s_add_u32 s75, s75, 1056768
    s_waitcnt lgkmcnt(1)
    buffer_store_dwordx4 v[156:159], v25, s[32:35], s75 offen sc1
    s_add_u32 s75, s75, 1056768
    s_waitcnt lgkmcnt(0)
    buffer_store_dwordx4 v[160:163], v25, s[32:35], s75 offen sc1
    v_and_b32 v180, 15, v0
    v_lshrrev_b32 v181, 2, v180
    v_lshlrev_b32 v181, 3, v181
    v_and_b32 v180, 3, v180
    v_add_u32 v180, v180, v181
    v_cvt_f32_u32 v193, v180
    s_mov_b32 s76, 0x35000000
    v_mul_f32 v192, 0x3d000000, v193
    v_mul_f32 v180, v240, v192
    v_mul_f32 v181, v241, v192
    v_mul_f32 v182, v242, v192
    v_mul_f32 v183, v243, v192
    v_fract_f32 v180, v180
    v_fract_f32 v181, v181
    v_fract_f32 v182, v182
    v_fract_f32 v183, v183
    v_cos_f32 v184, v180
    v_cos_f32 v185, v181
    v_cos_f32 v186, v182
    v_cos_f32 v187, v183
    v_sin_f32 v188, v180
    v_sin_f32 v189, v181
    v_sin_f32 v190, v182
    v_sin_f32 v191, v183
    v_mul_f32 v184, s76, v184
    v_mul_f32 v185, s76, v185
    v_mul_f32 v186, s76, v186
    v_mul_f32 v187, s76, v187
    v_mul_f32 v188, s76, v188
    v_mul_f32 v189, s76, v189
    v_mul_f32 v190, s76, v190
    v_mul_f32 v191, s76, v191
    v_cvt_pk_bf16_f32 v58, v184, v185
    v_cvt_pk_bf16_f32 v59, v186, v187
    v_cvt_pk_bf16_f32 v60, v188, v189
    v_cvt_pk_bf16_f32 v61, v190, v191
    v_xor_b32 v56, 2147516416, v60
    v_xor_b32 v57, 2147516416, v61
    v_mul_f32 v180, v244, v192
    v_mul_f32 v181, v245, v192
    v_mul_f32 v182, v246, v192
    v_mul_f32 v183, v247, v192
    v_fract_f32 v180, v180
    v_fract_f32 v181, v181
    v_fract_f32 v182, v182
    v_fract_f32 v183, v183
    v_cos_f32 v184, v180
    v_cos_f32 v185, v181
    v_cos_f32 v186, v182
    v_cos_f32 v187, v183
    v_sin_f32 v188, v180
    v_sin_f32 v189, v181
    v_sin_f32 v190, v182
    v_sin_f32 v191, v183
    v_mul_f32 v184, s76, v184
    v_mul_f32 v185, s76, v185
    v_mul_f32 v186, s76, v186
    v_mul_f32 v187, s76, v187
    v_mul_f32 v188, s76, v188
    v_mul_f32 v189, s76, v189
    v_mul_f32 v190, s76, v190
    v_mul_f32 v191, s76, v191
    v_cvt_pk_bf16_f32 v64, v184, v185
    v_cvt_pk_bf16_f32 v65, v186, v187
    v_cvt_pk_bf16_f32 v66, v188, v189
    v_cvt_pk_bf16_f32 v67, v190, v191
    v_xor_b32 v62, 2147516416, v66
    v_xor_b32 v63, 2147516416, v67
    v_mul_f32 v192, 0x3a800000, v193
    v_mul_f32 v180, v240, v192
    v_mul_f32 v181, v241, v192
    v_mul_f32 v182, v242, v192
    v_mul_f32 v183, v243, v192
    v_cos_f32 v80, v180
    v_cos_f32 v81, v181
    v_cos_f32 v82, v182
    v_cos_f32 v83, v183
    v_sin_f32 v84, v180
    v_sin_f32 v85, v181
    v_sin_f32 v86, v182
    v_sin_f32 v87, v183
    v_mul_f32 v180, v244, v192
    v_mul_f32 v181, v245, v192
    v_mul_f32 v182, v246, v192
    v_mul_f32 v183, v247, v192
    v_cos_f32 v88, v180
    v_cos_f32 v89, v181
    v_cos_f32 v90, v182
    v_cos_f32 v91, v183
    v_sin_f32 v92, v180
    v_sin_f32 v93, v181
    v_sin_f32 v94, v182
    v_sin_f32 v95, v183
    v_add_f32 v193, 4.0, v193
    v_mul_f32 v192, 0x3d000000, v193
    v_mul_f32 v180, v240, v192
    v_mul_f32 v181, v241, v192
    v_mul_f32 v182, v242, v192
    v_mul_f32 v183, v243, v192
    v_fract_f32 v180, v180
    v_fract_f32 v181, v181
    v_fract_f32 v182, v182
    v_fract_f32 v183, v183
    v_cos_f32 v184, v180
    v_cos_f32 v185, v181
    v_cos_f32 v186, v182
    v_cos_f32 v187, v183
    v_sin_f32 v188, v180
    v_sin_f32 v189, v181
    v_sin_f32 v190, v182
    v_sin_f32 v191, v183
    v_mul_f32 v184, s76, v184
    v_mul_f32 v185, s76, v185
    v_mul_f32 v186, s76, v186
    v_mul_f32 v187, s76, v187
    v_mul_f32 v188, s76, v188
    v_mul_f32 v189, s76, v189
    v_mul_f32 v190, s76, v190
    v_mul_f32 v191, s76, v191
    v_cvt_pk_bf16_f32 v70, v184, v185
    v_cvt_pk_bf16_f32 v71, v186, v187
    v_cvt_pk_bf16_f32 v72, v188, v189
    v_cvt_pk_bf16_f32 v73, v190, v191
    v_xor_b32 v68, 2147516416, v72
    v_xor_b32 v69, 2147516416, v73
    v_mul_f32 v180, v244, v192
    v_mul_f32 v181, v245, v192
    v_mul_f32 v182, v246, v192
    v_mul_f32 v183, v247, v192
    v_fract_f32 v180, v180
    v_fract_f32 v181, v181
    v_fract_f32 v182, v182
    v_fract_f32 v183, v183
    v_cos_f32 v184, v180
    v_cos_f32 v185, v181
    v_cos_f32 v186, v182
    v_cos_f32 v187, v183
    v_sin_f32 v188, v180
    v_sin_f32 v189, v181
    v_sin_f32 v190, v182
    v_sin_f32 v191, v183
    v_mul_f32 v184, s76, v184
    v_mul_f32 v185, s76, v185
    v_mul_f32 v186, s76, v186
    v_mul_f32 v187, s76, v187
    v_mul_f32 v188, s76, v188
    v_mul_f32 v189, s76, v189
    v_mul_f32 v190, s76, v190
    v_mul_f32 v191, s76, v191
    v_cvt_pk_bf16_f32 v76, v184, v185
    v_cvt_pk_bf16_f32 v77, v186, v187
    v_cvt_pk_bf16_f32 v78, v188, v189
    v_cvt_pk_bf16_f32 v79, v190, v191
    v_xor_b32 v74, 2147516416, v78
    v_xor_b32 v75, 2147516416, v79
    v_mul_f32 v192, 0x3a800000, v193
    v_mul_f32 v180, v240, v192
    v_mul_f32 v181, v241, v192
    v_mul_f32 v182, v242, v192
    v_mul_f32 v183, v243, v192
    v_cos_f32 v96, v180
    v_cos_f32 v97, v181
    v_cos_f32 v98, v182
    v_cos_f32 v99, v183
    v_sin_f32 v100, v180
    v_sin_f32 v101, v181
    v_sin_f32 v102, v182
    v_sin_f32 v103, v183
    v_mul_f32 v180, v244, v192
    v_mul_f32 v181, v245, v192
    v_mul_f32 v182, v246, v192
    v_mul_f32 v183, v247, v192
    v_cos_f32 v104, v180
    v_cos_f32 v105, v181
    v_cos_f32 v106, v182
    v_cos_f32 v107, v183
    v_sin_f32 v108, v180
    v_sin_f32 v109, v181
    v_sin_f32 v110, v182
    v_sin_f32 v111, v183
    s_waitcnt vmcnt(0)
    v_mov_b32 v212, 1
    s_mov_b64 exec, 1
    ds_add_rtn_u32 v213, v22, v212 offset:192
    s_waitcnt lgkmcnt(0)
    v_readfirstlane_b32 s75, v213
    s_mov_b64 exec, -1
    s_cmp_lg_u32 s75, 3
    s_cbranch_scc1 L_lf_66
    s_mov_b32 s60, s18
    s_mov_b32 s61, s19
    s_mov_b32 s62, 256
    s_mov_b32 s63, 0x00020000
    v_mov_b32 v212, 1
    v_mov_b32 v213, 0
    s_mov_b64 exec, 1
    buffer_atomic_add v212, v213, s[60:63], 0 offen sc0
    s_mov_b64 exec, -1
    s_waitcnt vmcnt(0)
    v_readfirstlane_b32 s75, v212
    s_and_b32 s75, s75, 255
    s_cmp_lg_u32 s75, 255
    s_cbranch_scc1 L_nl_67
    v_lshlrev_b32 v213, 7, v0
    s_mov_b32 s75, 21504
    s_mov_b64 exec, 0xff
    buffer_store_dword v20, v213, s[32:35], s75 offen sc1
    s_mov_b64 exec, -1
L_nl_67:
L_lf_66:
    s_lshl_b32 s76, s53, 6
    v_add_u32 v25, s76, v0
    v_lshrrev_b32 v192, 2, v25
    v_lshlrev_b32 v192, 1, v192
    v_and_b32 v193, 1, v25
    v_add_u32 v192, v192, v193
    v_sub_u32 v193, 1024, v192
    v_and_b32 v194, 2, v25
    v_cmp_eq_u32 vcc, 0, v194
    s_nop 1
    v_cndmask_b32 v192, v193, v192, vcc
    v_mov_b32 v193, 0xfffff800
    v_mov_b32 v194, 2048
    v_cndmask_b32 v193, v193, v194, vcc
    v_lshlrev_b32 v192, 4, v192
    v_add_u32 v26, 131072, v192
    v_add_u32 v27, v26, v193
    v_add_u32 v28, v27, v193
    v_add_u32 v29, v28, v193
    v_mov_b32 v194, 139264
    v_cmp_eq_u32 vcc, 2, v25
    s_nop 1
    v_cndmask_b32 v26, v26, v194, vcc
    v_lshlrev_b32 v25, 4, v25
    s_cmp_lg_u32 s53, 0
    s_cbranch_scc1 L_bw_68
    s_and_b32 s75, s2, 7
    s_lshl_b32 s75, s75, 7
    s_add_u32 s75, s75, 21504
    s_mov_b32 s57, 1048576
    s_mov_b64 exec, 1
L_pw_70:
    buffer_load_dword v192, v21, s[32:35], s75 offen sc1
    s_waitcnt vmcnt(0)
    v_cmp_ne_u32 vcc, s56, v192
    s_cbranch_vccz L_pwd_71
    s_sub_u32 s57, s57, 1
    s_cmp_lg_u32 s57, 0
    s_cbranch_scc1 L_pw_70
L_pwd_71:
    s_mov_b64 exec, -1
    s_mov_b64 exec, 15
    ds_write_b32 v22, v20 offset:208
    s_mov_b64 exec, -1
    s_branch L_bd_69
L_bw_68:
    s_mov_b32 s57, 1048576
L_lw_72:
    ds_read_b32 v192, v22 offset:208
    s_waitcnt lgkmcnt(0)
    v_cmp_ne_u32 vcc, s56, v192
    s_cbranch_vccz L_lwd_73
    s_sub_u32 s57, s57, 1
    s_cmp_lg_u32 s57, 0
    s_cbranch_scc1 L_lw_72
L_lwd_73:
L_bd_69:
    s_mul_i32 s75, s2, 16512
    s_add_u32 s75, s75, 25165824
    buffer_load_dwordx4 v[112:115], v25, s[32:35], s75 offen sc1
    s_add_u32 s75, s75, 4096
    buffer_load_dwordx4 v[116:119], v25, s[32:35], s75 offen sc1
    s_add_u32 s75, s75, 4096
    buffer_load_dwordx4 v[120:123], v25, s[32:35], s75 offen sc1
    s_add_u32 s75, s75, 4096
    buffer_load_dwordx4 v[124:127], v25, s[32:35], s75 offen sc1
    s_or_b32 s76, s2, s53
    s_cmp_lg_u32 s76, 0
    s_cbranch_scc1 L_ng_74
    s_mov_b64 exec, 1
    buffer_store_dword v20, v21, s[32:35], 0 offen sc1
    s_mov_b64 exec, -1
L_ng_74:
    v_lshrrev_b32 v192, 4, v0
    v_lshlrev_b32 v192, 11, v192
    v_and_b32 v193, 15, v0
    v_lshl_add_u32 v192, v193, 4, v192
    s_lshr_b32 s76, s53, 1
    s_lshl_b32 s76, s76, 2
    s_add_u32 s76, s76, 131072
    v_add_u32 v24, s76, v192
    v_add_u32 v25, 8, v24
    s_bitcmp1_b32 s53, 0
    s_mov_b32 s77, 0x05040100
    s_cselect_b32 s77, 0x07060302, s77
    s_waitcnt vmcnt(0)
    ds_write_b128 v26, v[112:115]
    ds_write_b128 v27, v[116:119]
    ds_write_b128 v28, v[120:123]
    ds_write_b128 v29, v[124:127]
    s_mov_b64 exec, 1
    ds_write_b32 v23, v20 offset:224
    s_mov_b64 exec, -1
    s_mov_b32 s57, 1048576
L_lw_75:
    ds_read_b32 v192, v22 offset:224
    s_waitcnt lgkmcnt(0)
    v_cmp_ne_u32 vcc, s56, v192
    s_cbranch_vccz L_lwd_76
    s_sub_u32 s57, s57, 1
    s_cmp_lg_u32 s57, 0
    s_cbranch_scc1 L_lw_75
L_lwd_76:
    ds_read2st64_b32 v[112:113], v25 offset0:0 offset1:2
    ds_read2st64_b32 v[114:115], v25 offset0:4 offset1:6
    ds_read2st64_b32 v[116:117], v24 offset0:0 offset1:2
    ds_read2st64_b32 v[118:119], v24 offset0:4 offset1:6
    ds_read2st64_b32 v[120:121], v25 offset0:32 offset1:34
    ds_read2st64_b32 v[122:123], v25 offset0:36 offset1:38
    ds_read2st64_b32 v[124:125], v24 offset0:32 offset1:34
    ds_read2st64_b32 v[126:127], v24 offset0:36 offset1:38
    ds_read2st64_b32 v[128:129], v25 offset0:1 offset1:3
    ds_read2st64_b32 v[130:131], v25 offset0:5 offset1:7
    ds_read2st64_b32 v[132:133], v24 offset0:1 offset1:3
    ds_read2st64_b32 v[134:135], v24 offset0:5 offset1:7
    ds_read2st64_b32 v[136:137], v25 offset0:33 offset1:35
    ds_read2st64_b32 v[138:139], v25 offset0:37 offset1:39
    ds_read2st64_b32 v[140:141], v24 offset0:33 offset1:35
    ds_read2st64_b32 v[142:143], v24 offset0:37 offset1:39
    s_mov_b32 s64, s16
    s_mov_b32 s65, s17
    s_mov_b32 s66, 8388608
    s_mov_b32 s67, 0x00020000
    s_lshr_b32 s75, s2, 5
    s_lshl_b32 s75, s75, 2
    s_add_u32 s75, s75, s53
    s_lshl_b32 s75, s75, 5
    s_and_b32 s76, s2, 31
    s_add_u32 s75, s75, s76
    s_lshl_b32 s75, s75, 13
    s_add_u32 s75, s75, 2048
    s_add_u32 s76, s75, 4096
    v_and_b32 v26, 15, v0
    v_lshlrev_b32 v26, 6, v26
    v_lshrrev_b32 v27, 4, v0
    v_lshl_add_u32 v26, v27, 4, v26
    s_waitcnt lgkmcnt(15)
    v_perm_b32 v144, v113, v112, s77
    s_waitcnt lgkmcnt(14)
    v_perm_b32 v145, v115, v114, s77
    s_waitcnt lgkmcnt(13)
    v_perm_b32 v146, v117, v116, s77
    s_waitcnt lgkmcnt(12)
    v_perm_b32 v147, v119, v118, s77
    s_waitcnt lgkmcnt(11)
    v_perm_b32 v148, v121, v120, s77
    s_waitcnt lgkmcnt(10)
    v_perm_b32 v149, v123, v122, s77
    s_waitcnt lgkmcnt(9)
    v_perm_b32 v150, v125, v124, s77
    s_waitcnt lgkmcnt(8)
    v_perm_b32 v151, v127, v126, s77
    v_mfma_f32_16x16x32_bf16 v[160:163], v[144:147], v[56:59], 0
    v_mfma_f32_16x16x32_bf16 v[164:167], v[144:147], v[58:61], 0
    v_mfma_f32_16x16x32_bf16 v[160:163], v[148:151], v[62:65], v[160:163]
    v_mfma_f32_16x16x32_bf16 v[164:167], v[148:151], v[64:67], v[164:167]
    v_mfma_f32_16x16x32_bf16 v[176:179], v[144:147], v[68:71], 0
    v_mfma_f32_16x16x32_bf16 v[180:183], v[144:147], v[70:73], 0
    v_mfma_f32_16x16x32_bf16 v[176:179], v[148:151], v[74:77], v[176:179]
    v_mfma_f32_16x16x32_bf16 v[180:183], v[148:151], v[76:79], v[180:183]
    s_waitcnt lgkmcnt(7)
    v_perm_b32 v152, v129, v128, s77
    s_waitcnt lgkmcnt(6)
    v_perm_b32 v153, v131, v130, s77
    s_waitcnt lgkmcnt(5)
    v_perm_b32 v154, v133, v132, s77
    s_waitcnt lgkmcnt(4)
    v_perm_b32 v155, v135, v134, s77
    s_waitcnt lgkmcnt(3)
    v_perm_b32 v156, v137, v136, s77
    s_waitcnt lgkmcnt(2)
    v_perm_b32 v157, v139, v138, s77
    s_waitcnt lgkmcnt(1)
    v_perm_b32 v158, v141, v140, s77
    s_waitcnt lgkmcnt(0)
    v_perm_b32 v159, v143, v142, s77
    v_mfma_f32_16x16x32_bf16 v[168:171], v[152:155], v[56:59], 0
    v_mfma_f32_16x16x32_bf16 v[172:175], v[152:155], v[58:61], 0
    v_mfma_f32_16x16x32_bf16 v[168:171], v[156:159], v[62:65], v[168:171]
    v_mfma_f32_16x16x32_bf16 v[172:175], v[156:159], v[64:67], v[172:175]
    v_mfma_f32_16x16x32_bf16 v[184:187], v[152:155], v[68:71], 0
    v_mfma_f32_16x16x32_bf16 v[188:191], v[152:155], v[70:73], 0
    v_mfma_f32_16x16x32_bf16 v[184:187], v[156:159], v[74:77], v[184:187]
    v_mfma_f32_16x16x32_bf16 v[188:191], v[156:159], v[76:79], v[188:191]
    v_pk_mul_f32 v[192:193], v[160:161], v[80:81]
    v_pk_mul_f32 v[194:195], v[162:163], v[82:83]
    v_pk_mul_f32 v[196:197], v[164:165], v[80:81]
    v_pk_mul_f32 v[198:199], v[166:167], v[82:83]
    v_pk_fma_f32 v[192:193], v[164:165], v[84:85], v[192:193] neg_lo:[1,0,0] neg_hi:[1,0,0]
    v_pk_fma_f32 v[194:195], v[166:167], v[86:87], v[194:195] neg_lo:[1,0,0] neg_hi:[1,0,0]
    v_pk_fma_f32 v[196:197], v[160:161], v[84:85], v[196:197]
    v_pk_fma_f32 v[198:199], v[162:163], v[86:87], v[198:199]
    v_cvt_pk_bf16_f32 v112, v196, v197
    v_cvt_pk_bf16_f32 v113, v198, v199
    v_cvt_pk_bf16_f32 v114, v192, v193
    v_cvt_pk_bf16_f32 v115, v194, v195
    v_pk_mul_f32 v[200:201], v[168:169], v[88:89]
    v_pk_mul_f32 v[202:203], v[170:171], v[90:91]
    v_pk_mul_f32 v[204:205], v[172:173], v[88:89]
    v_pk_mul_f32 v[206:207], v[174:175], v[90:91]
    v_pk_fma_f32 v[200:201], v[172:173], v[92:93], v[200:201] neg_lo:[1,0,0] neg_hi:[1,0,0]
    v_pk_fma_f32 v[202:203], v[174:175], v[94:95], v[202:203] neg_lo:[1,0,0] neg_hi:[1,0,0]
    v_pk_fma_f32 v[204:205], v[168:169], v[92:93], v[204:205]
    v_pk_fma_f32 v[206:207], v[170:171], v[94:95], v[206:207]
    v_cvt_pk_bf16_f32 v116, v204, v205
    v_cvt_pk_bf16_f32 v117, v206, v207
    v_cvt_pk_bf16_f32 v118, v200, v201
    v_cvt_pk_bf16_f32 v119, v202, v203
    v_pk_mul_f32 v[192:193], v[176:177], v[96:97]
    v_pk_mul_f32 v[194:195], v[178:179], v[98:99]
    v_pk_mul_f32 v[196:197], v[180:181], v[96:97]
    v_pk_mul_f32 v[198:199], v[182:183], v[98:99]
    v_pk_fma_f32 v[192:193], v[180:181], v[100:101], v[192:193] neg_lo:[1,0,0] neg_hi:[1,0,0]
    v_pk_fma_f32 v[194:195], v[182:183], v[102:103], v[194:195] neg_lo:[1,0,0] neg_hi:[1,0,0]
    v_pk_fma_f32 v[196:197], v[176:177], v[100:101], v[196:197]
    v_pk_fma_f32 v[198:199], v[178:179], v[102:103], v[198:199]
    v_cvt_pk_bf16_f32 v120, v196, v197
    v_cvt_pk_bf16_f32 v121, v198, v199
    v_cvt_pk_bf16_f32 v122, v192, v193
    v_cvt_pk_bf16_f32 v123, v194, v195
    v_pk_mul_f32 v[200:201], v[184:185], v[104:105]
    v_pk_mul_f32 v[202:203], v[186:187], v[106:107]
    v_pk_mul_f32 v[204:205], v[188:189], v[104:105]
    v_pk_mul_f32 v[206:207], v[190:191], v[106:107]
    v_pk_fma_f32 v[200:201], v[188:189], v[108:109], v[200:201] neg_lo:[1,0,0] neg_hi:[1,0,0]
    v_pk_fma_f32 v[202:203], v[190:191], v[110:111], v[202:203] neg_lo:[1,0,0] neg_hi:[1,0,0]
    v_pk_fma_f32 v[204:205], v[184:185], v[108:109], v[204:205]
    v_pk_fma_f32 v[206:207], v[186:187], v[110:111], v[206:207]
    v_cvt_pk_bf16_f32 v124, v204, v205
    v_cvt_pk_bf16_f32 v125, v206, v207
    v_cvt_pk_bf16_f32 v126, v200, v201
    v_cvt_pk_bf16_f32 v127, v202, v203
    v_mfma_f32_16x16x32_bf16 v[160:163], v[112:115], v[32:35], 0
    v_mfma_f32_16x16x32_bf16 v[164:167], v[112:115], v[34:37], 0
    v_mfma_f32_16x16x32_bf16 v[160:163], v[116:119], v[38:41], v[160:163]
    v_mfma_f32_16x16x32_bf16 v[164:167], v[116:119], v[40:43], v[164:167]
    v_mfma_f32_16x16x32_bf16 v[168:171], v[120:123], v[32:35], 0
    v_mfma_f32_16x16x32_bf16 v[172:175], v[120:123], v[34:37], 0
    v_mfma_f32_16x16x32_bf16 v[168:171], v[124:127], v[38:41], v[168:171]
    v_mfma_f32_16x16x32_bf16 v[172:175], v[124:127], v[40:43], v[172:175]
    v_mfma_f32_16x16x32_bf16 v[176:179], v[112:115], v[44:47], 0
    v_mfma_f32_16x16x32_bf16 v[180:183], v[112:115], v[46:49], 0
    v_mfma_f32_16x16x32_bf16 v[176:179], v[116:119], v[50:53], v[176:179]
    v_mfma_f32_16x16x32_bf16 v[180:183], v[116:119], v[52:55], v[180:183]
    v_mfma_f32_16x16x32_bf16 v[184:187], v[120:123], v[44:47], 0
    v_mfma_f32_16x16x32_bf16 v[188:191], v[120:123], v[46:49], 0
    v_mfma_f32_16x16x32_bf16 v[184:187], v[124:127], v[50:53], v[184:187]
    v_mfma_f32_16x16x32_bf16 v[188:191], v[124:127], v[52:55], v[188:191]
    v_cvt_pk_bf16_f32 v128, v160, v161
    v_cvt_pk_bf16_f32 v129, v162, v163
    v_cvt_pk_bf16_f32 v130, v168, v169
    v_cvt_pk_bf16_f32 v131, v170, v171
    buffer_store_dwordx4 v[128:131], v26, s[64:67], s75 offen offset:0 sc0 sc1
    v_cvt_pk_bf16_f32 v132, v164, v165
    v_cvt_pk_bf16_f32 v133, v166, v167
    v_cvt_pk_bf16_f32 v134, v172, v173
    v_cvt_pk_bf16_f32 v135, v174, v175
    buffer_store_dwordx4 v[132:135], v26, s[64:67], s76 offen offset:0 sc0 sc1
    v_cvt_pk_bf16_f32 v136, v176, v177
    v_cvt_pk_bf16_f32 v137, v178, v179
    v_cvt_pk_bf16_f32 v138, v184, v185
    v_cvt_pk_bf16_f32 v139, v186, v187
    buffer_store_dwordx4 v[136:139], v26, s[64:67], s75 offen offset:1024 sc0 sc1
    v_cvt_pk_bf16_f32 v140, v180, v181
    v_cvt_pk_bf16_f32 v141, v182, v183
    v_cvt_pk_bf16_f32 v142, v188, v189
    v_cvt_pk_bf16_f32 v143, v190, v191
    buffer_store_dwordx4 v[140:143], v26, s[64:67], s76 offen offset:1024 sc0 sc1
    s_waitcnt vmcnt(0)
    s_waitcnt vmcnt(0)
L_exit:
    s_endpgm

.section .rodata,"a"
.p2align 6
.amdhsa_kernel concat_heads__linear_attn_block__spectral_gfnet__prompt_kernel
  .amdhsa_next_free_vgpr 256
  .amdhsa_next_free_sgpr 102
  .amdhsa_accum_offset 256
  .amdhsa_group_segment_fixed_size 0
  .amdhsa_kernarg_size 72
  .amdhsa_user_sgpr_count 2
  .amdhsa_user_sgpr_kernarg_segment_ptr 1
  .amdhsa_system_sgpr_workgroup_id_x 1
.end_amdhsa_kernel
```
